```python
import torch

def _softmax(x, axis=-1):
    return torch.softmax(x, dim=axis)
def _gelu(x):
    return torch.nn.functional.gelu(x, approximate="tanh")
def _silu(x):
    return torch.nn.functional.silu(x)
def _sigmoid(x):
    return torch.sigmoid(x)
def _layernorm(x, axis=-1, eps=1e-5):
    m = x.mean(dim=axis, keepdim=True)
    v = x.var(dim=axis, keepdim=True, unbiased=False)
    return (x - m) / torch.sqrt(v + eps)
def _scatter_add(tgt, idx, src, axis=0):
    return tgt.clone().index_add_(axis, idx, src)
def _segment_sum(src, seg, n):
    out = torch.zeros((n,) + src.shape[1:], dtype=src.dtype)
    return out.index_add_(0, seg, src)
def _pad(x, pw):
    flat = tuple(v for pair in reversed(pw) for v in pair)
    return torch.nn.functional.pad(x, flat)

kernel_name = 'gated_mix__sliding_block_cached__swiglu_ffn__decode'

def setup_inputs():

    _w = (lambda a: (lambda t: t.to(torch.bfloat16) if t.is_floating_point() else t)(torch.as_tensor(a)))
    def _A_setup():
        B, Sq, D = 8, 1, 576
        Hq, Hkv, Sk, Dh = 32, 16, 4096, 128
        assert Hq % Hkv == 0, (Hq, Hkv)
        return {
            "x": _w((lambda *s: torch.randn(*s, dtype=torch.bfloat16) * 0.05)(B, Sq, D)),
            "k_cache": _w((lambda *s: torch.randn(*s, dtype=torch.bfloat16) * 3.2)(B, Hkv, Sk, Dh)),
            "v_cache": _w((lambda *s: torch.randn(*s, dtype=torch.bfloat16) * 0.4)(B, Hkv, Sk, Dh)),
            "wq": _w((lambda *s: torch.randn(*s, dtype=torch.bfloat16) * 3.2)(D, Hq * Dh) * (D ** -0.5)),
            "wo": _w((lambda *s: torch.randn(*s, dtype=torch.bfloat16) * 0.4)(Hq * Dh, D) * ((Hq * Dh) ** -0.5)),
        }
    _A_in = _A_setup()

    def _B_setup():
        B, S, D, F = 8, 1, 576, 4608
        return {
            "x": _w((lambda *s: torch.randn(*s, dtype=torch.bfloat16) * 0.05)(B, S, D)),
            "w_gate": _w((lambda *s: torch.randn(*s, dtype=torch.bfloat16) * 0.05)(D, F)),
            "w_up": _w((lambda *s: torch.randn(*s, dtype=torch.bfloat16) * 0.05)(D, F)),
            "w_down": _w((lambda *s: torch.randn(*s, dtype=torch.bfloat16) * 0.05)(F, D)),
        }
    _B_in = _B_setup()

    return {
        "A_x": _A_in["x"],
        "A_k_cache": _A_in["k_cache"],
        "A_v_cache": _A_in["v_cache"],
        "A_wq": _A_in["wq"],
        "A_wo": _A_in["wo"],
        "B_x": _B_in["x"],
        "B_w_gate": _B_in["w_gate"],
        "B_w_up": _B_in["w_up"],
        "B_w_down": _B_in["w_down"],
        "gate_w": _w((lambda *s: torch.randn(*s, dtype=torch.bfloat16) * 0.05)(576) * 16.0),
    }

def reference(A_x, A_k_cache, A_v_cache, A_wq, A_wo, B_x, B_w_gate, B_w_up, B_w_down, gate_w):
    def _A_ref(x, k_cache, v_cache, wq, wo):
        B, Sq, D = x.shape
        Hq, Dh = 32, 128
        Hkv, Sk = k_cache.shape[1], k_cache.shape[2]
        W = min(4096, max(256, Sk // 4))
        rep = Hq // Hkv
        q = (lambda x, *d: x.permute(*d))((x @ wq).reshape(B, Sq, Hq, Dh), 0, 2, 1, 3)
        k = (lambda x, n, axis: torch.repeat_interleave(x, n, dim=axis))(k_cache[:, :, Sk - W:, :], rep, axis=1)
        v = (lambda x, n, axis: torch.repeat_interleave(x, n, dim=axis))(v_cache[:, :, Sk - W:, :], rep, axis=1)
        scores = torch.einsum("bhqd,bhkd->bhqk", q, k) * (Dh ** -0.5)
        p = _softmax(scores, axis=-1)
        o = torch.einsum("bhqk,bhkd->bhqd", p, v)
        return (lambda x, *d: x.permute(*d))(o, 0, 2, 1, 3).reshape(B, Sq, Hq * Dh) @ wo

    def _B_ref(x, w_gate, w_up, w_down):
        g = _silu(x @ w_gate)
        u = x @ w_up
        return (g * u) @ w_down

    x = A_x
    g = _sigmoid((x * gate_w).sum(-1, keepdims=True))
    a = _A_ref(x, A_k_cache, A_v_cache, A_wq, A_wo)
    b = _B_ref(x, B_w_gate, B_w_up, B_w_down)
    return g * a + (1 - g) * b
```

```asm
; @launch grid=(256,1,1) block=(256,1,1) lds=32768
.amdgcn_target "amdgcn-amd-amdhsa--gfx950"
.text
.globl gated_mix__sliding_block_cached__swiglu_ffn__decode_kernel
.p2align 8
.type gated_mix__sliding_block_cached__swiglu_ffn__decode_kernel,@function
gated_mix__sliding_block_cached__swiglu_ffn__decode_kernel:
    s_cmp_ge_u32 s2, 256
    s_cbranch_scc1 L_end
    s_load_dwordx16 s[16:31], s[0:1], 0
    s_load_dwordx8 s[32:39], s[0:1], 64
    s_load_dwordx2 s[40:41], s[0:1], 96
    v_lshrrev_b32 v12, 6, v0
    v_and_b32 v1, 63, v0
    v_readfirstlane_b32 s3, v12
    v_lshrrev_b32 v2, 4, v1
    v_and_b32 v3, 15, v1
    s_mov_b32 s9, 0x05040100
    s_mov_b32 s10, 0x07060302
    s_mov_b32 s15, 0x3e0293ee
    v_lshlrev_b32 v5, 4, v0
    v_and_b32 v13, 3, v1
    v_lshlrev_b32 v4, 4, v13
    v_lshl_add_u32 v4, v2, 6, v4
    v_bfe_u32 v13, v1, 2, 2
    v_lshl_add_u32 v4, v13, 8, v4
    v_lshl_add_u32 v4, v12, 10, v4
    s_mov_b32 s14, 0
    s_cmp_ge_u32 s2, 208
    s_cselect_b32 s14, 3, s14
    s_lshr_b32 s4, s2, 1
    s_bfe_u32 s5, s2, 0x30005
    s_xor_b32 s4, s4, s5
    s_lshr_b32 s43, s2, 3
    s_xor_b32 s43, s43, s2
    s_and_b32 s43, s43, 1
    s_mov_b32 s95, 32
    s_and_b32 s5, s2, 7
    s_cmp_eq_u32 s5, 3
    s_cselect_b32 s95, 30, s95
    s_cmp_eq_u32 s5, 2
    s_cselect_b32 s95, 34, s95
    s_cmp_ge_u32 s2, 208
    s_cselect_b32 s95, 32, s95
    s_sub_u32 s91, 64, s95
    s_mul_i32 s91, s91, s43
    s_lshl_b32 s91, s91, 12
    s_lshl_b32 s90, s95, 12
    s_lshl_b32 s89, s4, 20
    s_add_u32 s89, s89, s91
    s_add_u32 s89, s89, 0xC0000
    s_mov_b32 s46, s90
    s_mov_b32 s47, 0x20000
    s_mov_b32 s50, s90
    s_mov_b32 s51, 0x20000
    s_mov_b32 s54, 2621440
    s_mov_b32 s55, 0x20000
    s_mov_b32 s58, 9216
    s_mov_b32 s59, 0x20000
    s_mov_b32 s63, 0x20000
    s_mov_b32 s99, 0x20000
    v_bfe_u32 v12, v1, 3, 1
    v_lshlrev_b32 v12, 5, v12
    v_lshl_add_u32 v16, v2, 3, v12
    v_and_b32 v17, 7, v1
    v_lshlrev_b32 v17, 4, v17
    v_mul_u32_u24 v11, 1152, v16
    v_add_u32 v11, v11, v17
    v_and_b32 v12, 7, v1
    v_mul_u32_u24 v6, 1152, v12
    v_bfe_u32 v12, v1, 3, 1
    v_lshl_add_u32 v6, v12, 6, v6
    v_lshl_add_u32 v6, v2, 4, v6
    s_cmp_lt_u32 s2, 64
    s_movk_i32 s12, 9216
    s_mov_b32 s8, 5308416
    s_cselect_b32 s12, 8192, s12
    s_cselect_b32 s7, 0, 64
    s_cselect_b32 s8, 4718592, s8
    s_cmp_ge_u32 s2, 136
    s_cselect_b32 s7, 136, s7
    s_sub_u32 s7, s2, s7
    s_lshl_b32 s7, s7, 7
    s_sub_u32 s98, s8, s7
    v_mul_lo_u32 v8, v16, s12
    v_add_u32 v8, v8, v17
    s_lshl_b32 s42, s12, 6
    s_mul_i32 s86, s42, s3
    s_mul_i32 s88, s3, 73728
    s_mov_b32 s94, 0
    s_cmp_ge_u32 s2, 208
    s_waitcnt lgkmcnt(0)

    s_cbranch_scc1 L_nos1
    s_cmp_lt_u32 s2, 136
    s_cselect_b32 s5, s28, s30
    s_cselect_b32 s6, s29, s31
    s_cmp_lt_u32 s2, 64
    s_cselect_b32 s5, s22, s5
    s_cselect_b32 s6, s23, s6
    s_add_u32 s96, s5, s7
    s_addc_u32 s97, s6, 0
    s_and_b32 s97, s97, 0xffff
    s_mov_b32 s56, s16
    s_and_b32 s57, s17, 0xffff
    s_mov_b32 s52, s40
    s_and_b32 s53, s41, 0xffff
    s_and_b32 s5, s2, 0xc3
    s_or_b32 s5, s5, s3
    s_cmp_eq_u32 s5, 0
    s_cbranch_scc0 L_noinit
    s_lshl_b32 s5, s2, 6
    s_add_u32 s5, s5, 2097152
    v_mov_b32 v12, 0
    s_mov_b64 exec, 1
    buffer_store_dword v12, off, s[52:55], s5 sc1
    s_mov_b64 exec, -1
L_noinit:
    s_lshl_b32 s8, s3, 7
    buffer_load_dwordx4 v[44:47], v6, s[56:59], s8 offen offset:0
    s_mov_b32 s13, s86
    buffer_load_dwordx4 v[184:187], v8, s[96:99], s13 offen sc1 nt
    s_add_u32 s13, s13, s12
    buffer_load_dwordx4 v[188:191], v8, s[96:99], s13 offen sc1 nt
    s_add_u32 s13, s13, s12
    buffer_load_dwordx4 v[192:195], v8, s[96:99], s13 offen sc1 nt
    s_add_u32 s13, s13, s12
    buffer_load_dwordx4 v[196:199], v8, s[96:99], s13 offen sc1 nt
    s_add_u32 s13, s13, s12
    buffer_load_dwordx4 v[200:203], v8, s[96:99], s13 offen sc1 nt
    s_add_u32 s13, s13, s12
    buffer_load_dwordx4 v[204:207], v8, s[96:99], s13 offen sc1 nt
    s_add_u32 s13, s13, s12
    buffer_load_dwordx4 v[208:211], v8, s[96:99], s13 offen sc1 nt
    s_add_u32 s13, s13, s12
    buffer_load_dwordx4 v[212:215], v8, s[96:99], s13 offen sc1 nt
    s_lshl_b32 s8, s3, 7
    buffer_load_dwordx4 v[48:51], v6, s[56:59], s8 offen offset:512
    s_lshl_b32 s7, s42, 2
    s_add_u32 s13, s86, s7
    buffer_load_dwordx4 v[216:219], v8, s[96:99], s13 offen sc1 nt
    s_add_u32 s13, s13, s12
    buffer_load_dwordx4 v[220:223], v8, s[96:99], s13 offen sc1 nt
    s_add_u32 s13, s13, s12
    buffer_load_dwordx4 v[224:227], v8, s[96:99], s13 offen sc1 nt
    s_add_u32 s13, s13, s12
    buffer_load_dwordx4 v[228:231], v8, s[96:99], s13 offen sc1 nt
    s_add_u32 s13, s13, s12
    buffer_load_dwordx4 v[232:235], v8, s[96:99], s13 offen sc1 nt
    s_add_u32 s13, s13, s12
    buffer_load_dwordx4 v[236:239], v8, s[96:99], s13 offen sc1 nt
    s_add_u32 s13, s13, s12
    buffer_load_dwordx4 v[240:243], v8, s[96:99], s13 offen sc1 nt
    s_add_u32 s13, s13, s12
    buffer_load_dwordx4 v[244:247], v8, s[96:99], s13 offen sc1 nt
    s_lshl_b32 s8, s3, 2
    buffer_load_dword v52, v6, s[56:59], s8 offen offset:1024
    s_lshl_b32 s7, s42, 3
    s_lshl_b32 s8, s3, 1
    s_mul_i32 s8, s8, s12
    s_add_u32 s13, s7, s8
    buffer_load_dwordx4 v[248:251], v8, s[96:99], s13 offen sc1 nt
    s_add_u32 s13, s13, s12
    buffer_load_dwordx4 v[252:255], v8, s[96:99], s13 offen sc1 nt
    s_load_dword s84, s[40:41], 0
    s_mov_b32 s52, s40
    s_and_b32 s53, s41, 0xffff
    s_add_u32 s44, s18, s89
    s_addc_u32 s45, s19, 0
    s_and_b32 s45, s45, 0xffff
    s_add_u32 s48, s20, s89
    s_addc_u32 s49, s21, 0
    s_and_b32 s49, s49, 0xffff
    buffer_load_dwordx4 a[0:3], v4, s[44:47], s94 offen sc1 nt
    s_addk_i32 s94, 0x1000
    v_and_b32 v12, 7, v1
    v_and_b32 v13, 1, v12
    v_cmp_eq_u32 vcc, 1, v13
    v_mov_b32 v14, 0xffff
    v_mov_b32 v15, 0xffff0000
    v_cndmask_b32 v14, v14, v15, vcc
    v_lshrrev_b32 v12, 1, v12
    v_cmp_eq_u32 vcc, 0, v12
    s_nop 1
    v_cndmask_b32 v40, 0, v14, vcc
    v_cmp_eq_u32 vcc, 1, v12
    s_nop 1
    v_cndmask_b32 v41, 0, v14, vcc
    v_cmp_eq_u32 vcc, 2, v12
    s_nop 1
    v_cndmask_b32 v42, 0, v14, vcc
    v_cmp_eq_u32 vcc, 3, v12
    s_nop 1
    v_cndmask_b32 v43, 0, v14, vcc
    v_and_b32 v12, 1, v2
    v_mul_u32_u24 v35, 1152, v12
    v_lshrrev_b32 v12, 5, v1
    v_lshl_add_u32 v35, v12, 7, v35
    v_and_b32 v12, 7, v1
    v_lshl_add_u32 v35, v12, 4, v35
    s_lshl_b32 s5, s3, 8
    v_add_u32 v35, s5, v35
    v_bfe_u32 v12, v1, 3, 1
    v_lshlrev_b32 v12, 1, v12
    v_lshrrev_b32 v13, 1, v2
    v_add_u32 v12, v12, v13
    v_lshlrev_b32 v10, 13, v12
    v_and_b32 v12, 1, v2
    v_lshl_add_u32 v10, v12, 7, v10
    v_and_b32 v12, 3, v1
    v_lshl_add_u32 v10, v12, 5, v10
    s_and_b32 s6, s4, 15
    s_lshr_b32 s5, s4, 4
    s_mul_i32 s101, s6, 24576
    s_lshl_b32 s7, s5, 1
    s_add_u32 s7, s7, s43
    s_mul_i32 s7, s7, 1536
    s_add_u32 s101, s101, s7
    s_mul_i32 s7, s3, 384
    s_add_u32 s101, s101, s7
    s_add_u32 s101, s101, 2228224
    s_lshl_b32 s6, s6, 2
    s_add_u32 s6, s6, 1
    s_lshl_b32 s6, s6, 13
    s_lshl_b32 s5, s5, 8
    s_add_u32 s92, s5, s6
    s_add_u32 s92, s92, 2048
    v_lshlrev_b32 v9, 4, v1
    s_and_b32 s5, s4, 15
    s_lshl_b32 s5, s5, 8
    s_add_u32 s42, s5, 2097152
    s_waitcnt lgkmcnt(0)
    s_mul_i32 s84, s84, 1664525
    s_add_u32 s84, s84, 1013904223
    v_mov_b32 v7, s84
    v_mov_b32 v37, 1
    s_waitcnt vmcnt(13)
    v_perm_b32 v56, v188, v184, s9
    v_perm_b32 v57, v196, v192, s9
    v_perm_b32 v58, v204, v200, s9
    v_perm_b32 v59, v212, v208, s9
    v_perm_b32 v60, v188, v184, s10
    v_perm_b32 v61, v196, v192, s10
    v_perm_b32 v62, v204, v200, s10
    v_perm_b32 v63, v212, v208, s10
    v_perm_b32 v64, v189, v185, s9
    v_perm_b32 v65, v197, v193, s9
    v_perm_b32 v66, v205, v201, s9
    v_perm_b32 v67, v213, v209, s9
    v_mfma_f32_16x16x32_bf16 v[72:75], v[56:59], v[44:47], 0
    v_mfma_f32_16x16x32_bf16 v[76:79], v[60:63], v[44:47], 0
    v_perm_b32 v68, v189, v185, s10
    v_perm_b32 v69, v197, v193, s10
    v_perm_b32 v70, v205, v201, s10
    v_perm_b32 v71, v213, v209, s10
    v_perm_b32 v56, v190, v186, s9
    v_perm_b32 v57, v198, v194, s9
    v_perm_b32 v58, v206, v202, s9
    v_perm_b32 v59, v214, v210, s9
    v_mfma_f32_16x16x32_bf16 v[80:83], v[64:67], v[44:47], 0
    v_mfma_f32_16x16x32_bf16 v[84:87], v[68:71], v[44:47], 0
    v_perm_b32 v60, v190, v186, s10
    v_perm_b32 v61, v198, v194, s10
    v_perm_b32 v62, v206, v202, s10
    v_perm_b32 v63, v214, v210, s10
    v_perm_b32 v64, v191, v187, s9
    v_perm_b32 v65, v199, v195, s9
    v_perm_b32 v66, v207, v203, s9
    v_perm_b32 v67, v215, v211, s9
    v_mfma_f32_16x16x32_bf16 v[88:91], v[56:59], v[44:47], 0
    v_mfma_f32_16x16x32_bf16 v[92:95], v[60:63], v[44:47], 0
    v_perm_b32 v68, v191, v187, s10
    v_perm_b32 v69, v199, v195, s10
    v_perm_b32 v70, v207, v203, s10
    v_perm_b32 v71, v215, v211, s10
    s_nop 1
    v_mfma_f32_16x16x32_bf16 v[96:99], v[64:67], v[44:47], 0
    v_mfma_f32_16x16x32_bf16 v[100:103], v[68:71], v[44:47], 0
    buffer_load_dwordx4 a[4:7], v4, s[44:47], s94 offen sc1 nt
    s_addk_i32 s94, 0x1000
    buffer_load_dwordx4 a[8:11], v4, s[44:47], s94 offen sc1 nt
    s_addk_i32 s94, 0x1000
    buffer_load_dwordx4 a[12:15], v4, s[44:47], s94 offen sc1 nt
    s_addk_i32 s94, 0x1000
    buffer_load_dwordx4 a[16:19], v4, s[44:47], s94 offen sc1 nt
    s_addk_i32 s94, 0x1000
    buffer_load_dwordx4 a[20:23], v4, s[44:47], s94 offen sc1 nt
    s_addk_i32 s94, 0x1000
    buffer_load_dwordx4 a[24:27], v4, s[44:47], s94 offen sc1 nt
    s_addk_i32 s94, 0x1000
    s_waitcnt vmcnt(10)
    v_perm_b32 v56, v220, v216, s9
    v_perm_b32 v57, v228, v224, s9
    v_perm_b32 v58, v236, v232, s9
    v_perm_b32 v59, v244, v240, s9
    v_perm_b32 v60, v220, v216, s10
    v_perm_b32 v61, v228, v224, s10
    v_perm_b32 v62, v236, v232, s10
    v_perm_b32 v63, v244, v240, s10
    v_perm_b32 v64, v221, v217, s9
    v_perm_b32 v65, v229, v225, s9
    v_perm_b32 v66, v237, v233, s9
    v_perm_b32 v67, v245, v241, s9
    v_mfma_f32_16x16x32_bf16 v[72:75], v[56:59], v[48:51], v[72:75]
    v_mfma_f32_16x16x32_bf16 v[76:79], v[60:63], v[48:51], v[76:79]
    v_perm_b32 v68, v221, v217, s10
    v_perm_b32 v69, v229, v225, s10
    v_perm_b32 v70, v237, v233, s10
    v_perm_b32 v71, v245, v241, s10
    v_perm_b32 v56, v222, v218, s9
    v_perm_b32 v57, v230, v226, s9
    v_perm_b32 v58, v238, v234, s9
    v_perm_b32 v59, v246, v242, s9
    v_mfma_f32_16x16x32_bf16 v[80:83], v[64:67], v[48:51], v[80:83]
    v_mfma_f32_16x16x32_bf16 v[84:87], v[68:71], v[48:51], v[84:87]
    v_perm_b32 v60, v222, v218, s10
    v_perm_b32 v61, v230, v226, s10
    v_perm_b32 v62, v238, v234, s10
    v_perm_b32 v63, v246, v242, s10
    v_perm_b32 v64, v223, v219, s9
    v_perm_b32 v65, v231, v227, s9
    v_perm_b32 v66, v239, v235, s9
    v_perm_b32 v67, v247, v243, s9
    v_mfma_f32_16x16x32_bf16 v[88:91], v[56:59], v[48:51], v[88:91]
    v_mfma_f32_16x16x32_bf16 v[92:95], v[60:63], v[48:51], v[92:95]
    v_perm_b32 v68, v223, v219, s10
    v_perm_b32 v69, v231, v227, s10
    v_perm_b32 v70, v239, v235, s10
    v_perm_b32 v71, v247, v243, s10
    s_nop 1
    v_mfma_f32_16x16x32_bf16 v[96:99], v[64:67], v[48:51], v[96:99]
    v_mfma_f32_16x16x32_bf16 v[100:103], v[68:71], v[48:51], v[100:103]
    buffer_load_dwordx4 a[28:31], v4, s[44:47], s94 offen sc1 nt
    s_addk_i32 s94, 0x1000
    buffer_load_dwordx4 a[32:35], v4, s[44:47], s94 offen sc1 nt
    s_addk_i32 s94, 0x1000
    buffer_load_dwordx4 a[36:39], v4, s[44:47], s94 offen sc1 nt
    s_addk_i32 s94, 0x1000
    s_waitcnt vmcnt(10)
    v_mov_b32 v53, 0
    v_mov_b32 v54, 0
    v_mov_b32 v55, 0
    v_mov_b32 v57, 0
    v_mov_b32 v58, 0
    v_mov_b32 v59, 0
    v_mov_b32 v61, 0
    v_mov_b32 v62, 0
    v_mov_b32 v63, 0
    v_mov_b32 v65, 0
    v_mov_b32 v66, 0
    v_mov_b32 v67, 0
    v_mov_b32 v69, 0
    v_mov_b32 v70, 0
    v_mov_b32 v71, 0
    v_perm_b32 v56, v252, v248, s9
    v_perm_b32 v60, v252, v248, s10
    v_perm_b32 v64, v253, v249, s9
    v_perm_b32 v68, v253, v249, s10
    s_nop 0
    v_mfma_f32_16x16x32_bf16 v[72:75], v[56:59], v[52:55], v[72:75]
    v_mfma_f32_16x16x32_bf16 v[76:79], v[60:63], v[52:55], v[76:79]
    v_mfma_f32_16x16x32_bf16 v[80:83], v[64:67], v[52:55], v[80:83]
    v_mfma_f32_16x16x32_bf16 v[84:87], v[68:71], v[52:55], v[84:87]
    v_perm_b32 v56, v254, v250, s9
    v_perm_b32 v60, v254, v250, s10
    v_perm_b32 v64, v255, v251, s9
    v_perm_b32 v68, v255, v251, s10
    s_nop 0
    v_mfma_f32_16x16x32_bf16 v[88:91], v[56:59], v[52:55], v[88:91]
    v_mfma_f32_16x16x32_bf16 v[92:95], v[60:63], v[52:55], v[92:95]
    v_mfma_f32_16x16x32_bf16 v[96:99], v[64:67], v[52:55], v[96:99]
    v_mfma_f32_16x16x32_bf16 v[100:103], v[68:71], v[52:55], v[100:103]
    buffer_load_dwordx4 a[40:43], v4, s[44:47], s94 offen sc1 nt
    s_addk_i32 s94, 0x1000
    buffer_load_dwordx4 a[44:47], v4, s[44:47], s94 offen sc1 nt
    s_addk_i32 s94, 0x1000
    s_nop 4
    s_mov_b32 exec_lo, 0x00FF00FF
    s_mov_b32 exec_hi, 0xFF00FF00
    ds_write_b128 v35, v[72:75] offset:0
    ds_write_b128 v35, v[76:79] offset:2304
    ds_write_b128 v35, v[80:83] offset:4608
    ds_write_b128 v35, v[84:87] offset:6912
    ds_write_b128 v35, v[88:91] offset:9216
    ds_write_b128 v35, v[92:95] offset:11520
    ds_write_b128 v35, v[96:99] offset:13824
    ds_write_b128 v35, v[100:103] offset:16128
    s_mov_b64 exec, -1
    s_waitcnt lgkmcnt(0)
    s_barrier
    buffer_load_dwordx4 a[48:51], v4, s[44:47], s94 offen sc1 nt
    s_addk_i32 s94, 0x1000
    s_cmp_ge_u32 s3, 2
    s_cbranch_scc1 L_s1_done
    v_lshrrev_b32 v12, 2, v1
    v_mul_u32_u24 v36, 1152, v12
    v_and_b32 v13, 3, v1
    v_lshl_add_u32 v36, v13, 4, v36
    s_lshl_b32 s5, s3, 6
    v_add_u32 v36, s5, v36
    ds_read_b128 v[104:107], v36 offset:0
    ds_read_b128 v[108:111], v36 offset:128
    ds_read_b128 v[112:115], v36 offset:256
    ds_read_b128 v[116:119], v36 offset:384
    ds_read_b128 v[120:123], v36 offset:512
    ds_read_b128 v[124:127], v36 offset:640
    ds_read_b128 v[128:131], v36 offset:768
    ds_read_b128 v[132:135], v36 offset:896
    s_waitcnt lgkmcnt(6)
    v_add_f32 v104, v104, v108
    v_add_f32 v105, v105, v109
    v_add_f32 v106, v106, v110
    v_add_f32 v107, v107, v111
    s_waitcnt lgkmcnt(5)
    v_add_f32 v104, v104, v112
    v_add_f32 v105, v105, v113
    v_add_f32 v106, v106, v114
    v_add_f32 v107, v107, v115
    s_waitcnt lgkmcnt(4)
    v_add_f32 v104, v104, v116
    v_add_f32 v105, v105, v117
    v_add_f32 v106, v106, v118
    v_add_f32 v107, v107, v119
    s_waitcnt lgkmcnt(3)
    v_add_f32 v104, v104, v120
    v_add_f32 v105, v105, v121
    v_add_f32 v106, v106, v122
    v_add_f32 v107, v107, v123
    s_waitcnt lgkmcnt(2)
    v_add_f32 v104, v104, v124
    v_add_f32 v105, v105, v125
    v_add_f32 v106, v106, v126
    v_add_f32 v107, v107, v127
    s_waitcnt lgkmcnt(1)
    v_add_f32 v104, v104, v128
    v_add_f32 v105, v105, v129
    v_add_f32 v106, v106, v130
    v_add_f32 v107, v107, v131
    s_waitcnt lgkmcnt(0)
    v_add_f32 v104, v104, v132
    v_add_f32 v105, v105, v133
    v_add_f32 v106, v106, v134
    v_add_f32 v107, v107, v135
    v_and_b32 v12, 3, v1
    v_lshlrev_b32 v12, 7, v12
    v_bfe_u32 v13, v1, 2, 1
    v_lshl_add_u32 v12, v13, 6, v12
    v_lshrrev_b32 v13, 3, v1
    v_lshl_add_u32 v12, v13, 1, v12
    s_lshl_b32 s5, s3, 9
    s_add_u32 s5, s5, 18432
    v_add_u32 v12, s5, v12
    v_cvt_pk_bf16_f32 v108, v104, v105
    v_cvt_pk_bf16_f32 v109, v106, v107
    s_nop 0
    ds_write_b16 v12, v108
    ds_write_b16_d16_hi v12, v108 offset:16
    ds_write_b16 v12, v109 offset:32
    ds_write_b16_d16_hi v12, v109 offset:48
    v_lshlrev_b32 v13, 4, v1
    v_add_u32 v13, s5, v13
    s_add_u32 s6, s2, 1
    s_lshl_b32 s6, s6, 13
    s_waitcnt lgkmcnt(0)
    ds_read_b128 v[112:115], v13
    s_cmp_lt_u32 s2, 64
    s_cbranch_scc0 L_tile_gu
    s_lshl_b32 s5, s3, 10
    s_add_u32 s5, s5, s6
    v_lshlrev_b32 v14, 5, v1
    s_waitcnt lgkmcnt(0)
    s_mov_b32 exec_hi, 0
    v_mov_b32 v120, v112
    v_mov_b32 v121, v7
    v_mov_b32 v122, v113
    v_mov_b32 v123, v7
    v_mov_b32 v124, v114
    v_mov_b32 v125, v7
    v_mov_b32 v126, v115
    v_mov_b32 v127, v7
    buffer_store_dwordx4 v[120:123], v14, s[52:55], s5 offen offset:2048 sc1
    buffer_store_dwordx4 v[124:127], v14, s[52:55], s5 offen offset:2064 sc1
    s_mov_b64 exec, -1
    s_branch L_s1_done
L_tile_gu:
    s_lshl_b32 s5, s3, 6
    s_add_u32 s5, s5, s6
    v_and_b32 v14, 3, v1
    v_lshlrev_b32 v14, 8, v14
    v_bfe_u32 v15, v1, 2, 1
    v_lshl_add_u32 v14, v15, 7, v14
    v_bfe_u32 v15, v1, 3, 2
    v_lshl_add_u32 v14, v15, 4, v14
    s_waitcnt lgkmcnt(0)
    s_mov_b32 exec_hi, 0
    v_mov_b32 v120, v112
    v_mov_b32 v121, v7
    v_mov_b32 v122, v113
    v_mov_b32 v123, v7
    v_mov_b32 v124, v114
    v_mov_b32 v125, v7
    v_mov_b32 v126, v115
    v_mov_b32 v127, v7
    buffer_store_dwordx4 v[120:123], v14, s[52:55], s5 offen offset:2048 sc1
    buffer_store_dwordx4 v[124:127], v14, s[52:55], s5 offen offset:3072 sc1
    s_mov_b64 exec, -1
L_s1_done:
    buffer_load_dwordx4 a[52:55], v4, s[44:47], s94 offen sc1 nt
    s_addk_i32 s94, 0x1000
    buffer_load_dwordx4 a[56:59], v4, s[44:47], s94 offen sc1 nt
    s_addk_i32 s94, 0x1000
    buffer_load_dwordx4 a[60:63], v4, s[44:47], s94 offen sc1 nt
    s_addk_i32 s94, 0x1000
    buffer_load_dwordx4 a[64:67], v4, s[44:47], s94 offen sc1 nt
    s_addk_i32 s94, 0x1000
    buffer_load_dwordx4 a[68:71], v4, s[44:47], s94 offen sc1 nt
    s_addk_i32 s94, 0x1000
    buffer_load_dwordx4 a[72:75], v4, s[44:47], s94 offen sc1 nt
    s_addk_i32 s94, 0x1000
    buffer_load_dwordx4 a[76:79], v4, s[44:47], s94 offen sc1 nt
    s_addk_i32 s94, 0x1000
    buffer_load_dwordx4 a[80:83], v4, s[44:47], s94 offen sc1 nt
    s_addk_i32 s94, 0x1000
    buffer_load_dwordx4 a[84:87], v4, s[44:47], s94 offen sc1 nt
    s_addk_i32 s94, 0x1000
    buffer_load_dwordx4 a[88:91], v4, s[44:47], s94 offen sc1 nt
    s_addk_i32 s94, 0x1000
    buffer_load_dwordx4 a[92:95], v4, s[44:47], s94 offen sc1 nt
    s_addk_i32 s94, 0x1000
    buffer_load_dwordx4 a[96:99], v4, s[44:47], s94 offen sc1 nt
    s_addk_i32 s94, 0x1000
    buffer_load_dwordx4 a[100:103], v4, s[44:47], s94 offen sc1 nt
    s_addk_i32 s94, 0x1000
    buffer_load_dwordx4 a[104:107], v4, s[44:47], s94 offen sc1 nt
    s_addk_i32 s94, 0x1000
    buffer_load_dwordx4 a[108:111], v4, s[44:47], s94 offen sc1 nt
    s_addk_i32 s94, 0x1000
    buffer_load_dwordx4 a[112:115], v4, s[44:47], s94 offen sc1 nt
    s_addk_i32 s94, 0x1000
    buffer_load_dwordx4 a[116:119], v4, s[44:47], s94 offen sc1 nt
    s_addk_i32 s94, 0x1000
    s_cmp_eq_u32 s95, 30
    s_cbranch_scc1 L_seg2_30
    buffer_load_dwordx4 a[120:123], v4, s[44:47], s94 offen sc1 nt
    s_addk_i32 s94, 0x1000
    buffer_load_dwordx4 a[124:127], v4, s[44:47], s94 offen sc1 nt
    s_addk_i32 s94, 0x1000
    s_cmp_eq_u32 s95, 32
    s_cbranch_scc1 L_seg2_32
    buffer_load_dwordx4 a[128:131], v4, s[44:47], s94 offen sc1 nt
    s_addk_i32 s94, 0x1000
    buffer_load_dwordx4 a[132:135], v4, s[44:47], s94 offen sc1 nt
    s_addk_i32 s94, 0x1000
    s_branch L_seg2_34
L_nos1:
    s_load_dword s84, s[40:41], 0
    s_mov_b32 s52, s40
    s_and_b32 s53, s41, 0xffff
    s_add_u32 s44, s18, s89
    s_addc_u32 s45, s19, 0
    s_and_b32 s45, s45, 0xffff
    s_add_u32 s48, s20, s89
    s_addc_u32 s49, s21, 0
    s_and_b32 s49, s49, 0xffff
    s_sub_u32 s8, s2, 175
    s_add_u32 s100, s8, 145
    s_mul_i32 s5, s8, 57
    s_lshr_b32 s5, s5, 9
    s_mul_i32 s6, s5, 9
    s_sub_u32 s6, s8, s6
    s_mov_b32 s87, s5
    s_mul_i32 s7, s5, 589824
    s_lshl_b32 s8, s6, 7
    s_add_u32 s7, s7, s8
    s_add_u32 s88, s88, s7
    s_mov_b32 s60, s32
    s_and_b32 s61, s33, 0xffff
    s_mov_b32 s62, 5308416
    s_lshl_b32 s100, s100, 13
    s_add_u32 s100, s100, 4096
    s_add_u32 s13, s88, 0
    buffer_load_dwordx4 v[192:195], v11, s[60:63], s13 offen offset:0 sc1 nt
    buffer_load_dwordx4 v[196:199], v11, s[60:63], s13 offen offset:1152 sc1 nt
    buffer_load_dwordx4 v[200:203], v11, s[60:63], s13 offen offset:2304 sc1 nt
    buffer_load_dwordx4 v[204:207], v11, s[60:63], s13 offen offset:3456 sc1 nt
    s_add_u32 s13, s88, 4608
    buffer_load_dwordx4 v[208:211], v11, s[60:63], s13 offen offset:0 sc1 nt
    buffer_load_dwordx4 v[212:215], v11, s[60:63], s13 offen offset:1152 sc1 nt
    buffer_load_dwordx4 v[216:219], v11, s[60:63], s13 offen offset:2304 sc1 nt
    buffer_load_dwordx4 v[220:223], v11, s[60:63], s13 offen offset:3456 sc1 nt
    s_add_u32 s13, s88, 294912
    buffer_load_dwordx4 v[224:227], v11, s[60:63], s13 offen offset:0 sc1 nt
    buffer_load_dwordx4 v[228:231], v11, s[60:63], s13 offen offset:1152 sc1 nt
    buffer_load_dwordx4 v[232:235], v11, s[60:63], s13 offen offset:2304 sc1 nt
    buffer_load_dwordx4 v[236:239], v11, s[60:63], s13 offen offset:3456 sc1 nt
    s_add_u32 s13, s88, 299520
    buffer_load_dwordx4 v[240:243], v11, s[60:63], s13 offen offset:0 sc1 nt
    buffer_load_dwordx4 v[244:247], v11, s[60:63], s13 offen offset:1152 sc1 nt
    buffer_load_dwordx4 v[248:251], v11, s[60:63], s13 offen offset:2304 sc1 nt
    buffer_load_dwordx4 v[252:255], v11, s[60:63], s13 offen offset:3456 sc1 nt
    buffer_load_dwordx4 a[0:3], v4, s[44:47], s94 offen sc1 nt
    s_addk_i32 s94, 0x1000
    v_and_b32 v12, 7, v1
    v_and_b32 v13, 1, v12
    v_cmp_eq_u32 vcc, 1, v13
    v_mov_b32 v14, 0xffff
    v_mov_b32 v15, 0xffff0000
    v_cndmask_b32 v14, v14, v15, vcc
    v_lshrrev_b32 v12, 1, v12
    v_cmp_eq_u32 vcc, 0, v12
    s_nop 1
    v_cndmask_b32 v40, 0, v14, vcc
    v_cmp_eq_u32 vcc, 1, v12
    s_nop 1
    v_cndmask_b32 v41, 0, v14, vcc
    v_cmp_eq_u32 vcc, 2, v12
    s_nop 1
    v_cndmask_b32 v42, 0, v14, vcc
    v_cmp_eq_u32 vcc, 3, v12
    s_nop 1
    v_cndmask_b32 v43, 0, v14, vcc
    v_and_b32 v12, 1, v2
    v_mul_u32_u24 v35, 1152, v12
    v_lshrrev_b32 v12, 5, v1
    v_lshl_add_u32 v35, v12, 7, v35
    v_and_b32 v12, 7, v1
    v_lshl_add_u32 v35, v12, 4, v35
    s_lshl_b32 s5, s3, 8
    v_add_u32 v35, s5, v35
    v_bfe_u32 v12, v1, 3, 1
    v_lshlrev_b32 v12, 1, v12
    v_lshrrev_b32 v13, 1, v2
    v_add_u32 v12, v12, v13
    v_lshlrev_b32 v10, 13, v12
    v_and_b32 v12, 1, v2
    v_lshl_add_u32 v10, v12, 7, v10
    v_and_b32 v12, 3, v1
    v_lshl_add_u32 v10, v12, 5, v10
    s_and_b32 s6, s4, 15
    s_lshr_b32 s5, s4, 4
    s_mul_i32 s101, s6, 24576
    s_lshl_b32 s7, s5, 1
    s_add_u32 s7, s7, s43
    s_mul_i32 s7, s7, 1536
    s_add_u32 s101, s101, s7
    s_mul_i32 s7, s3, 384
    s_add_u32 s101, s101, s7
    s_add_u32 s101, s101, 2228224
    s_lshl_b32 s6, s6, 2
    s_add_u32 s6, s6, 1
    s_lshl_b32 s6, s6, 13
    s_lshl_b32 s5, s5, 8
    s_add_u32 s92, s5, s6
    s_add_u32 s92, s92, 2048
    v_lshlrev_b32 v9, 4, v1
    s_and_b32 s5, s4, 15
    s_lshl_b32 s5, s5, 8
    s_add_u32 s42, s5, 2097152
    s_waitcnt lgkmcnt(0)
    s_mul_i32 s84, s84, 1664525
    s_add_u32 s84, s84, 1013904223
    v_mov_b32 v7, s84
    v_mov_b32 v37, 1
    s_lshl_b32 s5, s87, 3
    s_add_u32 s5, s5, s3
    s_add_u32 s5, s5, 65
    s_lshl_b32 s5, s5, 13
    s_add_u32 s93, s5, 2048
    buffer_load_dwordx4 a[4:7], v4, s[44:47], s94 offen sc1 nt
    s_addk_i32 s94, 0x1000
    buffer_load_dwordx4 a[8:11], v4, s[44:47], s94 offen sc1 nt
    s_addk_i32 s94, 0x1000
    buffer_load_dwordx4 a[12:15], v4, s[44:47], s94 offen sc1 nt
    s_addk_i32 s94, 0x1000
    buffer_load_dwordx4 a[16:19], v4, s[44:47], s94 offen sc1 nt
    s_addk_i32 s94, 0x1000
    buffer_load_dwordx4 a[20:23], v4, s[44:47], s94 offen sc1 nt
    s_addk_i32 s94, 0x1000
    buffer_load_dwordx4 a[24:27], v4, s[44:47], s94 offen sc1 nt
    s_addk_i32 s94, 0x1000
    buffer_load_dwordx4 a[28:31], v4, s[44:47], s94 offen sc1 nt
    s_addk_i32 s94, 0x1000
    buffer_load_dwordx4 a[32:35], v4, s[44:47], s94 offen sc1 nt
    s_addk_i32 s94, 0x1000
    buffer_load_dwordx4 a[36:39], v4, s[44:47], s94 offen sc1 nt
    s_addk_i32 s94, 0x1000
    buffer_load_dwordx4 a[40:43], v4, s[44:47], s94 offen sc1 nt
    s_addk_i32 s94, 0x1000
    buffer_load_dwordx4 a[44:47], v4, s[44:47], s94 offen sc1 nt
    s_addk_i32 s94, 0x1000
    buffer_load_dwordx4 a[48:51], v4, s[44:47], s94 offen sc1 nt
    s_addk_i32 s94, 0x1000
    buffer_load_dwordx4 a[52:55], v4, s[44:47], s94 offen sc1 nt
    s_addk_i32 s94, 0x1000
    buffer_load_dwordx4 a[56:59], v4, s[44:47], s94 offen sc1 nt
    s_addk_i32 s94, 0x1000
    buffer_load_dwordx4 a[60:63], v4, s[44:47], s94 offen sc1 nt
    s_addk_i32 s94, 0x1000
    buffer_load_dwordx4 a[64:67], v4, s[44:47], s94 offen sc1 nt
    s_addk_i32 s94, 0x1000
    buffer_load_dwordx4 a[68:71], v4, s[44:47], s94 offen sc1 nt
    s_addk_i32 s94, 0x1000
    buffer_load_dwordx4 a[72:75], v4, s[44:47], s94 offen sc1 nt
    s_addk_i32 s94, 0x1000
    buffer_load_dwordx4 a[76:79], v4, s[44:47], s94 offen sc1 nt
    s_addk_i32 s94, 0x1000
    buffer_load_dwordx4 a[80:83], v4, s[44:47], s94 offen sc1 nt
    s_addk_i32 s94, 0x1000
    buffer_load_dwordx4 a[84:87], v4, s[44:47], s94 offen sc1 nt
    s_addk_i32 s94, 0x1000
    buffer_load_dwordx4 a[88:91], v4, s[44:47], s94 offen sc1 nt
    s_addk_i32 s94, 0x1000
    buffer_load_dwordx4 a[92:95], v4, s[44:47], s94 offen sc1 nt
    s_addk_i32 s94, 0x1000
    buffer_load_dwordx4 a[96:99], v4, s[44:47], s94 offen sc1 nt
    s_addk_i32 s94, 0x1000
    buffer_load_dwordx4 a[100:103], v4, s[44:47], s94 offen sc1 nt
    s_addk_i32 s94, 0x1000
    buffer_load_dwordx4 a[104:107], v4, s[44:47], s94 offen sc1 nt
    s_addk_i32 s94, 0x1000
    buffer_load_dwordx4 a[108:111], v4, s[44:47], s94 offen sc1 nt
    s_addk_i32 s94, 0x1000
    buffer_load_dwordx4 a[112:115], v4, s[44:47], s94 offen sc1 nt
    s_addk_i32 s94, 0x1000
    buffer_load_dwordx4 a[116:119], v4, s[44:47], s94 offen sc1 nt
    s_addk_i32 s94, 0x1000
    buffer_load_dwordx4 a[120:123], v4, s[44:47], s94 offen sc1 nt
    s_addk_i32 s94, 0x1000
    buffer_load_dwordx4 a[124:127], v4, s[44:47], s94 offen sc1 nt
    s_addk_i32 s94, 0x1000
L_seg2_32:
    buffer_load_dwordx4 v[20:23], v10, s[52:55], s92 offen sc1
    buffer_load_dwordx4 v[24:27], v10, s[52:55], s92 offen offset:16 sc1
    s_mov_b32 s95, 0
    buffer_load_dwordx4 a[128:131], v5, s[48:51], s95 offen sc1 nt
    s_addk_i32 s95, 0x1000
    buffer_load_dwordx4 a[132:135], v5, s[48:51], s95 offen sc1 nt
    s_addk_i32 s95, 0x1000
    buffer_load_dwordx4 a[136:139], v5, s[48:51], s95 offen sc1 nt
    s_addk_i32 s95, 0x1000
    buffer_load_dwordx4 a[140:143], v5, s[48:51], s95 offen sc1 nt
    s_addk_i32 s95, 0x1000
    buffer_load_dwordx4 a[144:147], v5, s[48:51], s95 offen sc1 nt
    s_addk_i32 s95, 0x1000
    buffer_load_dwordx4 a[148:151], v5, s[48:51], s95 offen sc1 nt
    s_addk_i32 s95, 0x1000
    buffer_load_dwordx4 a[152:155], v5, s[48:51], s95 offen sc1 nt
    s_addk_i32 s95, 0x1000
    buffer_load_dwordx4 a[156:159], v5, s[48:51], s95 offen sc1 nt
    s_addk_i32 s95, 0x1000
    buffer_load_dwordx4 a[160:163], v5, s[48:51], s95 offen sc1 nt
    s_addk_i32 s95, 0x1000
    buffer_load_dwordx4 a[164:167], v5, s[48:51], s95 offen sc1 nt
    s_addk_i32 s95, 0x1000
    s_waitcnt vmcnt(10)
    v_xor_b32 v12, s84, v21
    v_bitop3_b32 v12, v23, s84, v12 bitop3:0xbe
    v_bitop3_b32 v12, v25, s84, v12 bitop3:0xbe
    v_bitop3_b32 v12, v27, s84, v12 bitop3:0xbe
    v_cmp_ne_u32 vcc, 0, v12
    s_cbranch_vccz L_qok2
    s_mov_b32 s85, 0
L_qspin3:
    buffer_load_dwordx4 v[20:23], v10, s[52:55], s92 offen sc1
    buffer_load_dwordx4 v[24:27], v10, s[52:55], s92 offen offset:16 sc1
    s_waitcnt vmcnt(0)
    v_xor_b32 v12, s84, v21
    v_bitop3_b32 v12, v23, s84, v12 bitop3:0xbe
    v_bitop3_b32 v12, v25, s84, v12 bitop3:0xbe
    v_bitop3_b32 v12, v27, s84, v12 bitop3:0xbe
    v_cmp_ne_u32 vcc, 0, v12
    s_cbranch_vccz L_qok2
    s_add_u32 s85, s85, 1
    s_cmp_gt_u32 s85, 4096
    s_cbranch_scc1 L_qok2
    s_sleep 2
    s_branch L_qspin3
L_qok2:
    v_mov_b32 v21, v22
    v_mov_b32 v22, v24
    v_mov_b32 v23, v26
    s_nop 1
    v_mfma_f32_16x16x32_bf16 v[144:147], a[0:3], v[20:23], 0
    v_mfma_f32_16x16x32_bf16 v[148:151], a[4:7], v[20:23], 0
    v_mfma_f32_16x16x32_bf16 v[152:155], a[8:11], v[20:23], 0
    v_mfma_f32_16x16x32_bf16 v[156:159], a[12:15], v[20:23], 0
    v_mfma_f32_16x16x32_bf16 v[160:163], a[16:19], v[20:23], 0
    v_mfma_f32_16x16x32_bf16 v[164:167], a[20:23], v[20:23], 0
    v_mfma_f32_16x16x32_bf16 v[168:171], a[24:27], v[20:23], 0
    v_mfma_f32_16x16x32_bf16 v[172:175], a[28:31], v[20:23], 0
    s_nop 3
    v_mov_b32_dpp v104, v144 quad_perm:[0,0,0,0] row_mask:0xf bank_mask:0xf
    v_mov_b32_dpp v105, v148 quad_perm:[0,0,0,0] row_mask:0xf bank_mask:0xf
    v_mov_b32_dpp v106, v152 quad_perm:[0,0,0,0] row_mask:0xf bank_mask:0xf
    v_mov_b32_dpp v107, v156 quad_perm:[0,0,0,0] row_mask:0xf bank_mask:0xf
    v_add_f32_dpp v104, v145, v104 quad_perm:[1,1,1,1] row_mask:0xf bank_mask:0xf
    v_add_f32_dpp v105, v149, v105 quad_perm:[1,1,1,1] row_mask:0xf bank_mask:0xf
    v_add_f32_dpp v106, v153, v106 quad_perm:[1,1,1,1] row_mask:0xf bank_mask:0xf
    v_add_f32_dpp v107, v157, v107 quad_perm:[1,1,1,1] row_mask:0xf bank_mask:0xf
    v_add_f32_dpp v104, v146, v104 quad_perm:[2,2,2,2] row_mask:0xf bank_mask:0xf
    v_add_f32_dpp v105, v150, v105 quad_perm:[2,2,2,2] row_mask:0xf bank_mask:0xf
    v_add_f32_dpp v106, v154, v106 quad_perm:[2,2,2,2] row_mask:0xf bank_mask:0xf
    v_add_f32_dpp v107, v158, v107 quad_perm:[2,2,2,2] row_mask:0xf bank_mask:0xf
    v_add_f32_dpp v104, v147, v104 quad_perm:[3,3,3,3] row_mask:0xf bank_mask:0xf
    v_add_f32_dpp v105, v151, v105 quad_perm:[3,3,3,3] row_mask:0xf bank_mask:0xf
    v_add_f32_dpp v106, v155, v106 quad_perm:[3,3,3,3] row_mask:0xf bank_mask:0xf
    v_add_f32_dpp v107, v159, v107 quad_perm:[3,3,3,3] row_mask:0xf bank_mask:0xf
    v_mfma_f32_16x16x32_bf16 v[144:147], a[32:35], v[20:23], 0
    v_mfma_f32_16x16x32_bf16 v[148:151], a[36:39], v[20:23], 0
    v_mfma_f32_16x16x32_bf16 v[152:155], a[40:43], v[20:23], 0
    v_mfma_f32_16x16x32_bf16 v[156:159], a[44:47], v[20:23], 0
    v_mov_b32_dpp v108, v160 quad_perm:[0,0,0,0] row_mask:0xf bank_mask:0xf
    v_mov_b32_dpp v109, v164 quad_perm:[0,0,0,0] row_mask:0xf bank_mask:0xf
    v_mov_b32_dpp v110, v168 quad_perm:[0,0,0,0] row_mask:0xf bank_mask:0xf
    v_mov_b32_dpp v111, v172 quad_perm:[0,0,0,0] row_mask:0xf bank_mask:0xf
    v_add_f32_dpp v108, v161, v108 quad_perm:[1,1,1,1] row_mask:0xf bank_mask:0xf
    v_add_f32_dpp v109, v165, v109 quad_perm:[1,1,1,1] row_mask:0xf bank_mask:0xf
    v_add_f32_dpp v110, v169, v110 quad_perm:[1,1,1,1] row_mask:0xf bank_mask:0xf
    v_add_f32_dpp v111, v173, v111 quad_perm:[1,1,1,1] row_mask:0xf bank_mask:0xf
    v_add_f32_dpp v108, v162, v108 quad_perm:[2,2,2,2] row_mask:0xf bank_mask:0xf
    v_add_f32_dpp v109, v166, v109 quad_perm:[2,2,2,2] row_mask:0xf bank_mask:0xf
    v_add_f32_dpp v110, v170, v110 quad_perm:[2,2,2,2] row_mask:0xf bank_mask:0xf
    v_add_f32_dpp v111, v174, v111 quad_perm:[2,2,2,2] row_mask:0xf bank_mask:0xf
    v_add_f32_dpp v108, v163, v108 quad_perm:[3,3,3,3] row_mask:0xf bank_mask:0xf
    v_add_f32_dpp v109, v167, v109 quad_perm:[3,3,3,3] row_mask:0xf bank_mask:0xf
    v_add_f32_dpp v110, v171, v110 quad_perm:[3,3,3,3] row_mask:0xf bank_mask:0xf
    v_add_f32_dpp v111, v175, v111 quad_perm:[3,3,3,3] row_mask:0xf bank_mask:0xf
    v_mfma_f32_16x16x32_bf16 v[160:163], a[48:51], v[20:23], 0
    v_mfma_f32_16x16x32_bf16 v[164:167], a[52:55], v[20:23], 0
    v_mfma_f32_16x16x32_bf16 v[168:171], a[56:59], v[20:23], 0
    v_mfma_f32_16x16x32_bf16 v[172:175], a[60:63], v[20:23], 0
    buffer_load_dwordx4 a[168:171], v5, s[48:51], s95 offen sc1 nt
    s_addk_i32 s95, 0x1000
    v_mov_b32_dpp v112, v144 quad_perm:[0,0,0,0] row_mask:0xf bank_mask:0xf
    v_mov_b32_dpp v113, v148 quad_perm:[0,0,0,0] row_mask:0xf bank_mask:0xf
    v_mov_b32_dpp v114, v152 quad_perm:[0,0,0,0] row_mask:0xf bank_mask:0xf
    v_mov_b32_dpp v115, v156 quad_perm:[0,0,0,0] row_mask:0xf bank_mask:0xf
    v_add_f32_dpp v112, v145, v112 quad_perm:[1,1,1,1] row_mask:0xf bank_mask:0xf
    v_add_f32_dpp v113, v149, v113 quad_perm:[1,1,1,1] row_mask:0xf bank_mask:0xf
    v_add_f32_dpp v114, v153, v114 quad_perm:[1,1,1,1] row_mask:0xf bank_mask:0xf
    v_add_f32_dpp v115, v157, v115 quad_perm:[1,1,1,1] row_mask:0xf bank_mask:0xf
    v_add_f32_dpp v112, v146, v112 quad_perm:[2,2,2,2] row_mask:0xf bank_mask:0xf
    v_add_f32_dpp v113, v150, v113 quad_perm:[2,2,2,2] row_mask:0xf bank_mask:0xf
    v_add_f32_dpp v114, v154, v114 quad_perm:[2,2,2,2] row_mask:0xf bank_mask:0xf
    v_add_f32_dpp v115, v158, v115 quad_perm:[2,2,2,2] row_mask:0xf bank_mask:0xf
    v_add_f32_dpp v112, v147, v112 quad_perm:[3,3,3,3] row_mask:0xf bank_mask:0xf
    v_add_f32_dpp v113, v151, v113 quad_perm:[3,3,3,3] row_mask:0xf bank_mask:0xf
    v_add_f32_dpp v114, v155, v114 quad_perm:[3,3,3,3] row_mask:0xf bank_mask:0xf
    v_add_f32_dpp v115, v159, v115 quad_perm:[3,3,3,3] row_mask:0xf bank_mask:0xf
    v_mfma_f32_16x16x32_bf16 v[144:147], a[64:67], v[20:23], 0
    v_mfma_f32_16x16x32_bf16 v[148:151], a[68:71], v[20:23], 0
    v_mfma_f32_16x16x32_bf16 v[152:155], a[72:75], v[20:23], 0
    v_mfma_f32_16x16x32_bf16 v[156:159], a[76:79], v[20:23], 0
    v_mov_b32_dpp v116, v160 quad_perm:[0,0,0,0] row_mask:0xf bank_mask:0xf
    v_mov_b32_dpp v117, v164 quad_perm:[0,0,0,0] row_mask:0xf bank_mask:0xf
    v_mov_b32_dpp v118, v168 quad_perm:[0,0,0,0] row_mask:0xf bank_mask:0xf
    v_mov_b32_dpp v119, v172 quad_perm:[0,0,0,0] row_mask:0xf bank_mask:0xf
    v_add_f32_dpp v116, v161, v116 quad_perm:[1,1,1,1] row_mask:0xf bank_mask:0xf
    v_add_f32_dpp v117, v165, v117 quad_perm:[1,1,1,1] row_mask:0xf bank_mask:0xf
    v_add_f32_dpp v118, v169, v118 quad_perm:[1,1,1,1] row_mask:0xf bank_mask:0xf
    v_add_f32_dpp v119, v173, v119 quad_perm:[1,1,1,1] row_mask:0xf bank_mask:0xf
    v_add_f32_dpp v116, v162, v116 quad_perm:[2,2,2,2] row_mask:0xf bank_mask:0xf
    v_add_f32_dpp v117, v166, v117 quad_perm:[2,2,2,2] row_mask:0xf bank_mask:0xf
    v_add_f32_dpp v118, v170, v118 quad_perm:[2,2,2,2] row_mask:0xf bank_mask:0xf
    v_add_f32_dpp v119, v174, v119 quad_perm:[2,2,2,2] row_mask:0xf bank_mask:0xf
    v_add_f32_dpp v116, v163, v116 quad_perm:[3,3,3,3] row_mask:0xf bank_mask:0xf
    v_add_f32_dpp v117, v167, v117 quad_perm:[3,3,3,3] row_mask:0xf bank_mask:0xf
    v_add_f32_dpp v118, v171, v118 quad_perm:[3,3,3,3] row_mask:0xf bank_mask:0xf
    v_add_f32_dpp v119, v175, v119 quad_perm:[3,3,3,3] row_mask:0xf bank_mask:0xf
    v_mfma_f32_16x16x32_bf16 v[160:163], a[80:83], v[20:23], 0
    v_mfma_f32_16x16x32_bf16 v[164:167], a[84:87], v[20:23], 0
    v_mfma_f32_16x16x32_bf16 v[168:171], a[88:91], v[20:23], 0
    v_mfma_f32_16x16x32_bf16 v[172:175], a[92:95], v[20:23], 0
    buffer_load_dwordx4 a[172:175], v5, s[48:51], s95 offen sc1 nt
    s_addk_i32 s95, 0x1000
    v_mov_b32_dpp v120, v144 quad_perm:[0,0,0,0] row_mask:0xf bank_mask:0xf
    v_mov_b32_dpp v121, v148 quad_perm:[0,0,0,0] row_mask:0xf bank_mask:0xf
    v_mov_b32_dpp v122, v152 quad_perm:[0,0,0,0] row_mask:0xf bank_mask:0xf
    v_mov_b32_dpp v123, v156 quad_perm:[0,0,0,0] row_mask:0xf bank_mask:0xf
    v_add_f32_dpp v120, v145, v120 quad_perm:[1,1,1,1] row_mask:0xf bank_mask:0xf
    v_add_f32_dpp v121, v149, v121 quad_perm:[1,1,1,1] row_mask:0xf bank_mask:0xf
    v_add_f32_dpp v122, v153, v122 quad_perm:[1,1,1,1] row_mask:0xf bank_mask:0xf
    v_add_f32_dpp v123, v157, v123 quad_perm:[1,1,1,1] row_mask:0xf bank_mask:0xf
    v_add_f32_dpp v120, v146, v120 quad_perm:[2,2,2,2] row_mask:0xf bank_mask:0xf
    v_add_f32_dpp v121, v150, v121 quad_perm:[2,2,2,2] row_mask:0xf bank_mask:0xf
    v_add_f32_dpp v122, v154, v122 quad_perm:[2,2,2,2] row_mask:0xf bank_mask:0xf
    v_add_f32_dpp v123, v158, v123 quad_perm:[2,2,2,2] row_mask:0xf bank_mask:0xf
    v_add_f32_dpp v120, v147, v120 quad_perm:[3,3,3,3] row_mask:0xf bank_mask:0xf
    v_add_f32_dpp v121, v151, v121 quad_perm:[3,3,3,3] row_mask:0xf bank_mask:0xf
    v_add_f32_dpp v122, v155, v122 quad_perm:[3,3,3,3] row_mask:0xf bank_mask:0xf
    v_add_f32_dpp v123, v159, v123 quad_perm:[3,3,3,3] row_mask:0xf bank_mask:0xf
    v_mfma_f32_16x16x32_bf16 v[144:147], a[96:99], v[20:23], 0
    v_mfma_f32_16x16x32_bf16 v[148:151], a[100:103], v[20:23], 0
    v_mfma_f32_16x16x32_bf16 v[152:155], a[104:107], v[20:23], 0
    v_mfma_f32_16x16x32_bf16 v[156:159], a[108:111], v[20:23], 0
    v_mov_b32_dpp v124, v160 quad_perm:[0,0,0,0] row_mask:0xf bank_mask:0xf
    v_mov_b32_dpp v125, v164 quad_perm:[0,0,0,0] row_mask:0xf bank_mask:0xf
    v_mov_b32_dpp v126, v168 quad_perm:[0,0,0,0] row_mask:0xf bank_mask:0xf
    v_mov_b32_dpp v127, v172 quad_perm:[0,0,0,0] row_mask:0xf bank_mask:0xf
    v_add_f32_dpp v124, v161, v124 quad_perm:[1,1,1,1] row_mask:0xf bank_mask:0xf
    v_add_f32_dpp v125, v165, v125 quad_perm:[1,1,1,1] row_mask:0xf bank_mask:0xf
    v_add_f32_dpp v126, v169, v126 quad_perm:[1,1,1,1] row_mask:0xf bank_mask:0xf
    v_add_f32_dpp v127, v173, v127 quad_perm:[1,1,1,1] row_mask:0xf bank_mask:0xf
    v_add_f32_dpp v124, v162, v124 quad_perm:[2,2,2,2] row_mask:0xf bank_mask:0xf
    v_add_f32_dpp v125, v166, v125 quad_perm:[2,2,2,2] row_mask:0xf bank_mask:0xf
    v_add_f32_dpp v126, v170, v126 quad_perm:[2,2,2,2] row_mask:0xf bank_mask:0xf
    v_add_f32_dpp v127, v174, v127 quad_perm:[2,2,2,2] row_mask:0xf bank_mask:0xf
    v_add_f32_dpp v124, v163, v124 quad_perm:[3,3,3,3] row_mask:0xf bank_mask:0xf
    v_add_f32_dpp v125, v167, v125 quad_perm:[3,3,3,3] row_mask:0xf bank_mask:0xf
    v_add_f32_dpp v126, v171, v126 quad_perm:[3,3,3,3] row_mask:0xf bank_mask:0xf
    v_add_f32_dpp v127, v175, v127 quad_perm:[3,3,3,3] row_mask:0xf bank_mask:0xf
    v_mfma_f32_16x16x32_bf16 v[160:163], a[112:115], v[20:23], 0
    v_mfma_f32_16x16x32_bf16 v[164:167], a[116:119], v[20:23], 0
    v_mfma_f32_16x16x32_bf16 v[168:171], a[120:123], v[20:23], 0
    v_mfma_f32_16x16x32_bf16 v[172:175], a[124:127], v[20:23], 0
    buffer_load_dwordx4 a[176:179], v5, s[48:51], s95 offen sc1 nt
    s_addk_i32 s95, 0x1000
    v_mov_b32_dpp v128, v144 quad_perm:[0,0,0,0] row_mask:0xf bank_mask:0xf
    v_mov_b32_dpp v129, v148 quad_perm:[0,0,0,0] row_mask:0xf bank_mask:0xf
    v_mov_b32_dpp v130, v152 quad_perm:[0,0,0,0] row_mask:0xf bank_mask:0xf
    v_mov_b32_dpp v131, v156 quad_perm:[0,0,0,0] row_mask:0xf bank_mask:0xf
    v_add_f32_dpp v128, v145, v128 quad_perm:[1,1,1,1] row_mask:0xf bank_mask:0xf
    v_add_f32_dpp v129, v149, v129 quad_perm:[1,1,1,1] row_mask:0xf bank_mask:0xf
    v_add_f32_dpp v130, v153, v130 quad_perm:[1,1,1,1] row_mask:0xf bank_mask:0xf
    v_add_f32_dpp v131, v157, v131 quad_perm:[1,1,1,1] row_mask:0xf bank_mask:0xf
    v_add_f32_dpp v128, v146, v128 quad_perm:[2,2,2,2] row_mask:0xf bank_mask:0xf
    v_add_f32_dpp v129, v150, v129 quad_perm:[2,2,2,2] row_mask:0xf bank_mask:0xf
    v_add_f32_dpp v130, v154, v130 quad_perm:[2,2,2,2] row_mask:0xf bank_mask:0xf
    v_add_f32_dpp v131, v158, v131 quad_perm:[2,2,2,2] row_mask:0xf bank_mask:0xf
    v_add_f32_dpp v128, v147, v128 quad_perm:[3,3,3,3] row_mask:0xf bank_mask:0xf
    v_add_f32_dpp v129, v151, v129 quad_perm:[3,3,3,3] row_mask:0xf bank_mask:0xf
    v_add_f32_dpp v130, v155, v130 quad_perm:[3,3,3,3] row_mask:0xf bank_mask:0xf
    v_add_f32_dpp v131, v159, v131 quad_perm:[3,3,3,3] row_mask:0xf bank_mask:0xf
    v_mov_b32_dpp v132, v160 quad_perm:[0,0,0,0] row_mask:0xf bank_mask:0xf
    v_mov_b32_dpp v133, v164 quad_perm:[0,0,0,0] row_mask:0xf bank_mask:0xf
    v_mov_b32_dpp v134, v168 quad_perm:[0,0,0,0] row_mask:0xf bank_mask:0xf
    v_mov_b32_dpp v135, v172 quad_perm:[0,0,0,0] row_mask:0xf bank_mask:0xf
    v_add_f32_dpp v132, v161, v132 quad_perm:[1,1,1,1] row_mask:0xf bank_mask:0xf
    v_add_f32_dpp v133, v165, v133 quad_perm:[1,1,1,1] row_mask:0xf bank_mask:0xf
    v_add_f32_dpp v134, v169, v134 quad_perm:[1,1,1,1] row_mask:0xf bank_mask:0xf
    v_add_f32_dpp v135, v173, v135 quad_perm:[1,1,1,1] row_mask:0xf bank_mask:0xf
    v_add_f32_dpp v132, v162, v132 quad_perm:[2,2,2,2] row_mask:0xf bank_mask:0xf
    v_add_f32_dpp v133, v166, v133 quad_perm:[2,2,2,2] row_mask:0xf bank_mask:0xf
    v_add_f32_dpp v134, v170, v134 quad_perm:[2,2,2,2] row_mask:0xf bank_mask:0xf
    v_add_f32_dpp v135, v174, v135 quad_perm:[2,2,2,2] row_mask:0xf bank_mask:0xf
    v_add_f32_dpp v132, v163, v132 quad_perm:[3,3,3,3] row_mask:0xf bank_mask:0xf
    v_add_f32_dpp v133, v167, v133 quad_perm:[3,3,3,3] row_mask:0xf bank_mask:0xf
    v_add_f32_dpp v134, v171, v134 quad_perm:[3,3,3,3] row_mask:0xf bank_mask:0xf
    v_add_f32_dpp v135, v175, v135 quad_perm:[3,3,3,3] row_mask:0xf bank_mask:0xf
    buffer_load_dwordx4 a[180:183], v5, s[48:51], s95 offen sc1 nt
    s_addk_i32 s95, 0x1000
    v_max3_f32 v32, v104, v105, v106
    v_max3_f32 v32, v32, v107, v108
    v_max3_f32 v32, v32, v109, v110
    v_max3_f32 v32, v32, v111, v112
    v_max3_f32 v32, v32, v113, v114
    v_max3_f32 v32, v32, v115, v116
    v_max3_f32 v32, v32, v117, v118
    v_max3_f32 v32, v32, v119, v120
    v_max3_f32 v32, v32, v121, v122
    v_max3_f32 v32, v32, v123, v124
    v_max3_f32 v32, v32, v125, v126
    v_max3_f32 v32, v32, v127, v128
    v_max3_f32 v32, v32, v129, v130
    v_max3_f32 v32, v32, v131, v132
    v_max3_f32 v32, v32, v133, v134
    v_max_f32 v32, v32, v135
    v_mov_b32 v12, v32
    s_nop 1
    v_permlane32_swap_b32 v32, v12
    s_nop 1
    v_max_f32 v32, v32, v12
    v_mov_b32 v12, v32
    s_nop 1
    v_permlane16_swap_b32 v32, v12
    s_nop 1
    v_max_f32 v32, v32, v12
    v_bfe_u32 v13, v1, 3, 1
    v_lshlrev_b32 v13, 4, v13
    s_lshl_b32 s5, s3, 2
    s_add_u32 s5, s5, 19456
    v_add_u32 v14, s5, v13
    v_add_u32 v15, 19456, v13
    s_mov_b64 exec, 0x101
    ds_write_b32 v14, v32
    s_mov_b64 exec, -1
    s_waitcnt lgkmcnt(0)
    s_barrier
    ds_read_b128 v[16:19], v15
    buffer_load_dwordx4 a[184:187], v5, s[48:51], s95 offen sc1 nt
    s_addk_i32 s95, 0x1000
    s_waitcnt lgkmcnt(0)
    v_max3_f32 v32, v16, v17, v18
    v_max_f32 v32, v32, v19
    v_mul_f32 v34, s15, v32
    v_mov_b32 v33, 0
    v_fma_f32 v104, v104, s15, -v34
    v_fma_f32 v105, v105, s15, -v34
    v_fma_f32 v106, v106, s15, -v34
    v_fma_f32 v107, v107, s15, -v34
    v_exp_f32 v104, v104
    v_exp_f32 v105, v105
    v_exp_f32 v106, v106
    v_exp_f32 v107, v107
    v_add_f32 v33, v33, v104
    v_add_f32 v33, v33, v105
    v_add_f32 v33, v33, v106
    v_add_f32 v33, v33, v107
    v_cvt_pk_bf16_f32 v104, v104, v104
    v_cvt_pk_bf16_f32 v105, v105, v105
    v_cvt_pk_bf16_f32 v106, v106, v106
    v_cvt_pk_bf16_f32 v107, v107, v107
    v_fma_f32 v108, v108, s15, -v34
    v_fma_f32 v109, v109, s15, -v34
    v_fma_f32 v110, v110, s15, -v34
    v_fma_f32 v111, v111, s15, -v34
    v_exp_f32 v108, v108
    v_exp_f32 v109, v109
    v_exp_f32 v110, v110
    v_exp_f32 v111, v111
    v_add_f32 v33, v33, v108
    v_add_f32 v33, v33, v109
    v_add_f32 v33, v33, v110
    v_add_f32 v33, v33, v111
    v_cvt_pk_bf16_f32 v108, v108, v108
    v_cvt_pk_bf16_f32 v109, v109, v109
    v_cvt_pk_bf16_f32 v110, v110, v110
    v_cvt_pk_bf16_f32 v111, v111, v111
    buffer_load_dwordx4 a[188:191], v5, s[48:51], s95 offen sc1 nt
    s_addk_i32 s95, 0x1000
    v_fma_f32 v112, v112, s15, -v34
    v_fma_f32 v113, v113, s15, -v34
    v_fma_f32 v114, v114, s15, -v34
    v_fma_f32 v115, v115, s15, -v34
    v_exp_f32 v112, v112
    v_exp_f32 v113, v113
    v_exp_f32 v114, v114
    v_exp_f32 v115, v115
    v_add_f32 v33, v33, v112
    v_add_f32 v33, v33, v113
    v_add_f32 v33, v33, v114
    v_add_f32 v33, v33, v115
    v_cvt_pk_bf16_f32 v112, v112, v112
    v_cvt_pk_bf16_f32 v113, v113, v113
    v_cvt_pk_bf16_f32 v114, v114, v114
    v_cvt_pk_bf16_f32 v115, v115, v115
    v_fma_f32 v116, v116, s15, -v34
    v_fma_f32 v117, v117, s15, -v34
    v_fma_f32 v118, v118, s15, -v34
    v_fma_f32 v119, v119, s15, -v34
    v_exp_f32 v116, v116
    v_exp_f32 v117, v117
    v_exp_f32 v118, v118
    v_exp_f32 v119, v119
    v_add_f32 v33, v33, v116
    v_add_f32 v33, v33, v117
    v_add_f32 v33, v33, v118
    v_add_f32 v33, v33, v119
    v_cvt_pk_bf16_f32 v116, v116, v116
    v_cvt_pk_bf16_f32 v117, v117, v117
    v_cvt_pk_bf16_f32 v118, v118, v118
    v_cvt_pk_bf16_f32 v119, v119, v119
    buffer_load_dwordx4 a[192:195], v5, s[48:51], s95 offen sc1 nt
    s_addk_i32 s95, 0x1000
    v_fma_f32 v120, v120, s15, -v34
    v_fma_f32 v121, v121, s15, -v34
    v_fma_f32 v122, v122, s15, -v34
    v_fma_f32 v123, v123, s15, -v34
    v_exp_f32 v120, v120
    v_exp_f32 v121, v121
    v_exp_f32 v122, v122
    v_exp_f32 v123, v123
    v_add_f32 v33, v33, v120
    v_add_f32 v33, v33, v121
    v_add_f32 v33, v33, v122
    v_add_f32 v33, v33, v123
    v_cvt_pk_bf16_f32 v120, v120, v120
    v_cvt_pk_bf16_f32 v121, v121, v121
    v_cvt_pk_bf16_f32 v122, v122, v122
    v_cvt_pk_bf16_f32 v123, v123, v123
    v_fma_f32 v124, v124, s15, -v34
    v_fma_f32 v125, v125, s15, -v34
    v_fma_f32 v126, v126, s15, -v34
    v_fma_f32 v127, v127, s15, -v34
    v_exp_f32 v124, v124
    v_exp_f32 v125, v125
    v_exp_f32 v126, v126
    v_exp_f32 v127, v127
    v_add_f32 v33, v33, v124
    v_add_f32 v33, v33, v125
    v_add_f32 v33, v33, v126
    v_add_f32 v33, v33, v127
    v_cvt_pk_bf16_f32 v124, v124, v124
    v_cvt_pk_bf16_f32 v125, v125, v125
    v_cvt_pk_bf16_f32 v126, v126, v126
    v_cvt_pk_bf16_f32 v127, v127, v127
    buffer_load_dwordx4 a[196:199], v5, s[48:51], s95 offen sc1 nt
    s_addk_i32 s95, 0x1000
    v_fma_f32 v128, v128, s15, -v34
    v_fma_f32 v129, v129, s15, -v34
    v_fma_f32 v130, v130, s15, -v34
    v_fma_f32 v131, v131, s15, -v34
    v_exp_f32 v128, v128
    v_exp_f32 v129, v129
    v_exp_f32 v130, v130
    v_exp_f32 v131, v131
    v_add_f32 v33, v33, v128
    v_add_f32 v33, v33, v129
    v_add_f32 v33, v33, v130
    v_add_f32 v33, v33, v131
    v_cvt_pk_bf16_f32 v128, v128, v128
    v_cvt_pk_bf16_f32 v129, v129, v129
    v_cvt_pk_bf16_f32 v130, v130, v130
    v_cvt_pk_bf16_f32 v131, v131, v131
    v_fma_f32 v132, v132, s15, -v34
    v_fma_f32 v133, v133, s15, -v34
    v_fma_f32 v134, v134, s15, -v34
    v_fma_f32 v135, v135, s15, -v34
    v_exp_f32 v132, v132
    v_exp_f32 v133, v133
    v_exp_f32 v134, v134
    v_exp_f32 v135, v135
    v_add_f32 v33, v33, v132
    v_add_f32 v33, v33, v133
    v_add_f32 v33, v33, v134
    v_add_f32 v33, v33, v135
    v_cvt_pk_bf16_f32 v132, v132, v132
    v_cvt_pk_bf16_f32 v133, v133, v133
    v_cvt_pk_bf16_f32 v134, v134, v134
    v_cvt_pk_bf16_f32 v135, v135, v135
    buffer_load_dwordx4 a[200:203], v5, s[48:51], s95 offen sc1 nt
    s_addk_i32 s95, 0x1000
    v_mov_b32 v12, v33
    s_nop 1
    v_permlane32_swap_b32 v33, v12
    s_nop 1
    v_add_f32 v33, v33, v12
    v_mov_b32 v12, v33
    s_nop 1
    v_permlane16_swap_b32 v33, v12
    s_nop 1
    v_add_f32 v33, v33, v12
    s_mov_b64 exec, 0x101
    ds_write_b32 v14, v33 offset:32
    s_mov_b64 exec, -1
    v_mov_b32 v28, 0
    v_mov_b32 v29, 0
    v_mov_b32 v30, 0
    v_mov_b32 v31, 0
    s_cmp_eq_u32 s14, 3
    s_cbranch_scc1 L_pv_32_3
L_pv_32_0:
    v_and_b32 v168, v104, v40
    v_and_b32 v169, v104, v41
    v_and_b32 v170, v104, v42
    v_and_b32 v171, v104, v43
    buffer_load_dwordx4 a[204:207], v5, s[48:51], s95 offen sc1 nt
    s_addk_i32 s95, 0x1000
    v_and_b32 v172, v105, v40
    v_and_b32 v173, v105, v41
    v_and_b32 v174, v105, v42
    v_and_b32 v175, v105, v43
    s_waitcnt vmcnt(19)
    v_mfma_f32_16x16x32_bf16 v[28:31], a[128:131], v[168:171], v[28:31]
    buffer_load_dwordx4 a[208:211], v5, s[48:51], s95 offen sc1 nt
    s_addk_i32 s95, 0x1000
    v_and_b32 v168, v106, v40
    v_and_b32 v169, v106, v41
    v_and_b32 v170, v106, v42
    v_and_b32 v171, v106, v43
    s_waitcnt vmcnt(19)
    v_mfma_f32_16x16x32_bf16 v[28:31], a[132:135], v[172:175], v[28:31]
    buffer_load_dwordx4 a[212:215], v5, s[48:51], s95 offen sc1 nt
    s_addk_i32 s95, 0x1000
    v_and_b32 v172, v107, v40
    v_and_b32 v173, v107, v41
    v_and_b32 v174, v107, v42
    v_and_b32 v175, v107, v43
    s_waitcnt vmcnt(19)
    v_mfma_f32_16x16x32_bf16 v[28:31], a[136:139], v[168:171], v[28:31]
    buffer_load_dwordx4 a[216:219], v5, s[48:51], s95 offen sc1 nt
    s_addk_i32 s95, 0x1000
    v_and_b32 v168, v108, v40
    v_and_b32 v169, v108, v41
    v_and_b32 v170, v108, v42
    v_and_b32 v171, v108, v43
    s_waitcnt vmcnt(19)
    v_mfma_f32_16x16x32_bf16 v[28:31], a[140:143], v[172:175], v[28:31]
    buffer_load_dwordx4 a[220:223], v5, s[48:51], s95 offen sc1 nt
    s_addk_i32 s95, 0x1000
    v_and_b32 v172, v109, v40
    v_and_b32 v173, v109, v41
    v_and_b32 v174, v109, v42
    v_and_b32 v175, v109, v43
    s_waitcnt vmcnt(19)
    v_mfma_f32_16x16x32_bf16 v[28:31], a[144:147], v[168:171], v[28:31]
    buffer_load_dwordx4 a[224:227], v5, s[48:51], s95 offen sc1 nt
    s_addk_i32 s95, 0x1000
    v_and_b32 v168, v110, v40
    v_and_b32 v169, v110, v41
    v_and_b32 v170, v110, v42
    v_and_b32 v171, v110, v43
    s_waitcnt vmcnt(19)
    v_mfma_f32_16x16x32_bf16 v[28:31], a[148:151], v[172:175], v[28:31]
    buffer_load_dwordx4 a[228:231], v5, s[48:51], s95 offen sc1 nt
    s_addk_i32 s95, 0x1000
    v_and_b32 v172, v111, v40
    v_and_b32 v173, v111, v41
    v_and_b32 v174, v111, v42
    v_and_b32 v175, v111, v43
    s_waitcnt vmcnt(19)
    v_mfma_f32_16x16x32_bf16 v[28:31], a[152:155], v[168:171], v[28:31]
    s_cmp_eq_u32 s3, 0
    s_cbranch_scc0 L_noclaim4
    s_mov_b64 exec, 1
    buffer_atomic_add v37, off, s[52:55], s42 sc0
    s_mov_b64 exec, -1
L_noclaim4:
    buffer_load_dwordx4 a[232:235], v5, s[48:51], s95 offen sc1 nt
    s_addk_i32 s95, 0x1000
    v_and_b32 v168, v112, v40
    v_and_b32 v169, v112, v41
    v_and_b32 v170, v112, v42
    v_and_b32 v171, v112, v43
    s_waitcnt vmcnt(19)
    v_mfma_f32_16x16x32_bf16 v[28:31], a[156:159], v[172:175], v[28:31]
    buffer_load_dwordx4 a[236:239], v5, s[48:51], s95 offen sc1 nt
    s_addk_i32 s95, 0x1000
    v_and_b32 v172, v113, v40
    v_and_b32 v173, v113, v41
    v_and_b32 v174, v113, v42
    v_and_b32 v175, v113, v43
    s_waitcnt vmcnt(19)
    v_mfma_f32_16x16x32_bf16 v[28:31], a[160:163], v[168:171], v[28:31]
    buffer_load_dwordx4 a[240:243], v5, s[48:51], s95 offen sc1 nt
    s_addk_i32 s95, 0x1000
    v_and_b32 v168, v114, v40
    v_and_b32 v169, v114, v41
    v_and_b32 v170, v114, v42
    v_and_b32 v171, v114, v43
    s_waitcnt vmcnt(19)
    v_mfma_f32_16x16x32_bf16 v[28:31], a[164:167], v[172:175], v[28:31]
    buffer_load_dwordx4 a[244:247], v5, s[48:51], s95 offen sc1 nt
    s_addk_i32 s95, 0x1000
    v_and_b32 v172, v115, v40
    v_and_b32 v173, v115, v41
    v_and_b32 v174, v115, v42
    v_and_b32 v175, v115, v43
    s_waitcnt vmcnt(19)
    v_mfma_f32_16x16x32_bf16 v[28:31], a[168:171], v[168:171], v[28:31]
    buffer_load_dwordx4 a[248:251], v5, s[48:51], s95 offen sc1 nt
    s_addk_i32 s95, 0x1000
    v_and_b32 v168, v116, v40
    v_and_b32 v169, v116, v41
    v_and_b32 v170, v116, v42
    v_and_b32 v171, v116, v43
    s_waitcnt vmcnt(19)
    v_mfma_f32_16x16x32_bf16 v[28:31], a[172:175], v[172:175], v[28:31]
    buffer_load_dwordx4 a[252:255], v5, s[48:51], s95 offen sc1 nt
    s_addk_i32 s95, 0x1000
    v_and_b32 v172, v117, v40
    v_and_b32 v173, v117, v41
    v_and_b32 v174, v117, v42
    v_and_b32 v175, v117, v43
    s_waitcnt vmcnt(19)
    v_mfma_f32_16x16x32_bf16 v[28:31], a[176:179], v[168:171], v[28:31]
    v_and_b32 v168, v118, v40
    v_and_b32 v169, v118, v41
    v_and_b32 v170, v118, v42
    v_and_b32 v171, v118, v43
    s_waitcnt vmcnt(18)
    v_mfma_f32_16x16x32_bf16 v[28:31], a[180:183], v[172:175], v[28:31]
    v_and_b32 v172, v119, v40
    v_and_b32 v173, v119, v41
    v_and_b32 v174, v119, v42
    v_and_b32 v175, v119, v43
    s_waitcnt vmcnt(17)
    v_mfma_f32_16x16x32_bf16 v[28:31], a[184:187], v[168:171], v[28:31]
    v_and_b32 v168, v120, v40
    v_and_b32 v169, v120, v41
    v_and_b32 v170, v120, v42
    v_and_b32 v171, v120, v43
    s_waitcnt vmcnt(16)
    v_mfma_f32_16x16x32_bf16 v[28:31], a[188:191], v[172:175], v[28:31]
    v_and_b32 v172, v121, v40
    v_and_b32 v173, v121, v41
    v_and_b32 v174, v121, v42
    v_and_b32 v175, v121, v43
    s_waitcnt vmcnt(15)
    v_mfma_f32_16x16x32_bf16 v[28:31], a[192:195], v[168:171], v[28:31]
    v_and_b32 v168, v122, v40
    v_and_b32 v169, v122, v41
    v_and_b32 v170, v122, v42
    v_and_b32 v171, v122, v43
    s_waitcnt vmcnt(14)
    v_mfma_f32_16x16x32_bf16 v[28:31], a[196:199], v[172:175], v[28:31]
    v_and_b32 v172, v123, v40
    v_and_b32 v173, v123, v41
    v_and_b32 v174, v123, v42
    v_and_b32 v175, v123, v43
    s_waitcnt vmcnt(13)
    v_mfma_f32_16x16x32_bf16 v[28:31], a[200:203], v[168:171], v[28:31]
    v_and_b32 v168, v124, v40
    v_and_b32 v169, v124, v41
    v_and_b32 v170, v124, v42
    v_and_b32 v171, v124, v43
    s_waitcnt vmcnt(12)
    v_mfma_f32_16x16x32_bf16 v[28:31], a[204:207], v[172:175], v[28:31]
    v_and_b32 v172, v125, v40
    v_and_b32 v173, v125, v41
    v_and_b32 v174, v125, v42
    v_and_b32 v175, v125, v43
    s_waitcnt vmcnt(11)
    v_mfma_f32_16x16x32_bf16 v[28:31], a[208:211], v[168:171], v[28:31]
    v_and_b32 v168, v126, v40
    v_and_b32 v169, v126, v41
    v_and_b32 v170, v126, v42
    v_and_b32 v171, v126, v43
    s_waitcnt vmcnt(10)
    v_mfma_f32_16x16x32_bf16 v[28:31], a[212:215], v[172:175], v[28:31]
    v_and_b32 v172, v127, v40
    v_and_b32 v173, v127, v41
    v_and_b32 v174, v127, v42
    v_and_b32 v175, v127, v43
    s_waitcnt vmcnt(9)
    v_mfma_f32_16x16x32_bf16 v[28:31], a[216:219], v[168:171], v[28:31]
    v_and_b32 v168, v128, v40
    v_and_b32 v169, v128, v41
    v_and_b32 v170, v128, v42
    v_and_b32 v171, v128, v43
    s_waitcnt vmcnt(8)
    v_mfma_f32_16x16x32_bf16 v[28:31], a[220:223], v[172:175], v[28:31]
    v_bfe_u32 v12, v1, 3, 1
    v_mul_u32_u24 v44, 800, v12
    v_mul_u32_u24 v12, 192, v2
    v_add_u32 v44, v44, v12
    v_and_b32 v13, 7, v1
    v_lshl_add_u32 v44, v13, 2, v44
    s_mul_i32 s5, s3, 1600
    s_add_u32 s5, s5, 24576
    v_add_u32 v44, s5, v44
    v_lshrrev_b32 v12, 3, v3
    v_mul_u32_u24 v45, 192, v12
    v_and_b32 v13, 7, v3
    v_lshl_add_u32 v45, v13, 4, v45
    s_lshr_b32 s5, s3, 1
    s_mul_i32 s5, s5, 800
    s_and_b32 s6, s3, 1
    s_mul_i32 s6, s6, 384
    s_add_u32 s5, s5, s6
    s_add_u32 s5, s5, 24576
    v_add_u32 v45, s5, v45
    v_and_b32 v12, 1, v3
    v_lshlrev_b32 v46, 7, v12
    v_lshrrev_b32 v12, 1, v3
    v_lshl_add_u32 v46, v12, 4, v46
    v_and_b32 v12, 7, v1
    v_lshlrev_b32 v12, 4, v12
    v_add_u32 v12, 256, v12
    v_cmp_lt_u32 vcc, 15, v1
    s_lshr_b32 s5, s3, 1
    s_lshl_b32 s5, s5, 3
    v_cndmask_b32 v46, v46, v12, vcc
    v_readlane_b32 s6, v32, s5
    s_nop 1
    v_mov_b32 v34, s6
    v_mul_f32 v34, s15, v34
    v_and_b32 v172, v129, v40
    v_and_b32 v173, v129, v41
    v_and_b32 v174, v129, v42
    v_and_b32 v175, v129, v43
    s_waitcnt vmcnt(7)
    v_mfma_f32_16x16x32_bf16 v[28:31], a[224:227], v[168:171], v[28:31]
    v_and_b32 v168, v130, v40
    v_and_b32 v169, v130, v41
    v_and_b32 v170, v130, v42
    v_and_b32 v171, v130, v43
    s_waitcnt vmcnt(6)
    v_mfma_f32_16x16x32_bf16 v[28:31], a[228:231], v[172:175], v[28:31]
    v_and_b32 v172, v131, v40
    v_and_b32 v173, v131, v41
    v_and_b32 v174, v131, v42
    v_and_b32 v175, v131, v43
    s_waitcnt vmcnt(5)
    v_mfma_f32_16x16x32_bf16 v[28:31], a[232:235], v[168:171], v[28:31]
    v_and_b32 v168, v132, v40
    v_and_b32 v169, v132, v41
    v_and_b32 v170, v132, v42
    v_and_b32 v171, v132, v43
    s_waitcnt vmcnt(4)
    v_mfma_f32_16x16x32_bf16 v[28:31], a[236:239], v[172:175], v[28:31]
    v_and_b32 v172, v133, v40
    v_and_b32 v173, v133, v41
    v_and_b32 v174, v133, v42
    v_and_b32 v175, v133, v43
    s_waitcnt vmcnt(3)
    v_mfma_f32_16x16x32_bf16 v[28:31], a[240:243], v[168:171], v[28:31]
    v_and_b32 v168, v134, v40
    v_and_b32 v169, v134, v41
    v_and_b32 v170, v134, v42
    v_and_b32 v171, v134, v43
    s_waitcnt vmcnt(2)
    v_mfma_f32_16x16x32_bf16 v[28:31], a[244:247], v[172:175], v[28:31]
    v_and_b32 v172, v135, v40
    v_and_b32 v173, v135, v41
    v_and_b32 v174, v135, v42
    v_and_b32 v175, v135, v43
    s_waitcnt vmcnt(1)
    v_mfma_f32_16x16x32_bf16 v[28:31], a[248:251], v[168:171], v[28:31]
    s_nop 1
    s_waitcnt vmcnt(0)
    v_mfma_f32_16x16x32_bf16 v[28:31], a[252:255], v[172:175], v[28:31]
    v_mov_b32 v13, 19584
    s_cmp_eq_u32 s3, 0
    s_cbranch_scc0 L_norank5
    s_waitcnt vmcnt(0)
    s_mov_b64 exec, 1
    ds_write_b32 v13, v37
    s_mov_b64 exec, -1
L_norank5:
    s_lshr_b32 s5, s3, 1
    s_lshl_b32 s5, s5, 4
    s_add_u32 s6, s5, 19456
    v_mov_b32 v15, s6
    v_mov_b32 v17, v7
    v_mov_b32 v19, v7
    s_nop 2
    ds_write_b32 v44, v28
    ds_write_b32 v44, v29 offset:32
    ds_write_b32 v44, v30 offset:64
    ds_write_b32 v44, v31 offset:96
    s_waitcnt lgkmcnt(0)
    s_barrier
    ds_read_b32 v37, v13
    ds_read_b128 v[88:91], v15 offset:32
    ds_read_b128 v[72:75], v45
    ds_read_b128 v[76:79], v45 offset:1600
    ds_read_b128 v[80:83], v45 offset:3200
    ds_read_b128 v[84:87], v45 offset:4800
    s_waitcnt lgkmcnt(4)
    v_add_f32 v88, v88, v89
    v_add_f32 v90, v90, v91
    s_waitcnt lgkmcnt(2)
    v_add_f32 v72, v72, v76
    v_add_f32 v73, v73, v77
    v_add_f32 v74, v74, v78
    v_add_f32 v75, v75, v79
    v_add_f32 v94, v88, v90
    s_waitcnt lgkmcnt(0)
    v_add_f32 v80, v80, v84
    v_add_f32 v81, v81, v85
    v_add_f32 v82, v82, v86
    v_add_f32 v83, v83, v87
    v_add_f32 v72, v72, v80
    v_add_f32 v73, v73, v81
    v_add_f32 v74, v74, v82
    v_add_f32 v75, v75, v83
    v_cvt_pk_bf16_f32 v16, v72, v73
    v_cvt_pk_bf16_f32 v18, v74, v75
    s_mov_b64 exec, 0xff0000
    v_mov_b32 v16, v34
    v_mov_b32 v18, v94
    s_mov_b64 exec, 0xffffff
    buffer_store_dwordx4 v[16:19], v46, s[52:55], s101 offen sc1
    s_mov_b64 exec, -1
    s_branch L_tail_0
L_pv_32_3:
    v_and_b32 v168, v104, v40
    v_and_b32 v169, v104, v41
    v_and_b32 v170, v104, v42
    v_and_b32 v171, v104, v43
    buffer_load_dwordx4 a[204:207], v5, s[48:51], s95 offen sc1 nt
    s_addk_i32 s95, 0x1000
    v_and_b32 v172, v105, v40
    v_and_b32 v173, v105, v41
    v_and_b32 v174, v105, v42
    v_and_b32 v175, v105, v43
    s_waitcnt vmcnt(19)
    v_mfma_f32_16x16x32_bf16 v[28:31], a[128:131], v[168:171], v[28:31]
    buffer_load_dwordx4 a[208:211], v5, s[48:51], s95 offen sc1 nt
    s_addk_i32 s95, 0x1000
    v_and_b32 v168, v106, v40
    v_and_b32 v169, v106, v41
    v_and_b32 v170, v106, v42
    v_and_b32 v171, v106, v43
    s_waitcnt vmcnt(19)
    v_mfma_f32_16x16x32_bf16 v[28:31], a[132:135], v[172:175], v[28:31]
    buffer_load_dwordx4 a[212:215], v5, s[48:51], s95 offen sc1 nt
    s_addk_i32 s95, 0x1000
    v_and_b32 v172, v107, v40
    v_and_b32 v173, v107, v41
    v_and_b32 v174, v107, v42
    v_and_b32 v175, v107, v43
    s_waitcnt vmcnt(19)
    v_mfma_f32_16x16x32_bf16 v[28:31], a[136:139], v[168:171], v[28:31]
    buffer_load_dwordx4 a[216:219], v5, s[48:51], s95 offen sc1 nt
    s_addk_i32 s95, 0x1000
    v_and_b32 v168, v108, v40
    v_and_b32 v169, v108, v41
    v_and_b32 v170, v108, v42
    v_and_b32 v171, v108, v43
    s_waitcnt vmcnt(19)
    v_mfma_f32_16x16x32_bf16 v[28:31], a[140:143], v[172:175], v[28:31]
    buffer_load_dwordx4 a[220:223], v5, s[48:51], s95 offen sc1 nt
    s_addk_i32 s95, 0x1000
    v_and_b32 v172, v109, v40
    v_and_b32 v173, v109, v41
    v_and_b32 v174, v109, v42
    v_and_b32 v175, v109, v43
    s_waitcnt vmcnt(19)
    v_mfma_f32_16x16x32_bf16 v[28:31], a[144:147], v[168:171], v[28:31]
    buffer_load_dwordx4 a[224:227], v5, s[48:51], s95 offen sc1 nt
    s_addk_i32 s95, 0x1000
    v_and_b32 v168, v110, v40
    v_and_b32 v169, v110, v41
    v_and_b32 v170, v110, v42
    v_and_b32 v171, v110, v43
    s_waitcnt vmcnt(19)
    v_mfma_f32_16x16x32_bf16 v[28:31], a[148:151], v[172:175], v[28:31]
    buffer_load_dwordx4 a[228:231], v5, s[48:51], s95 offen sc1 nt
    s_addk_i32 s95, 0x1000
    v_and_b32 v172, v111, v40
    v_and_b32 v173, v111, v41
    v_and_b32 v174, v111, v42
    v_and_b32 v175, v111, v43
    s_waitcnt vmcnt(19)
    v_mfma_f32_16x16x32_bf16 v[28:31], a[152:155], v[168:171], v[28:31]
    buffer_load_dwordx4 a[232:235], v5, s[48:51], s95 offen sc1 nt
    s_addk_i32 s95, 0x1000
    v_and_b32 v168, v112, v40
    v_and_b32 v169, v112, v41
    v_and_b32 v170, v112, v42
    v_and_b32 v171, v112, v43
    s_waitcnt vmcnt(19)
    v_mfma_f32_16x16x32_bf16 v[28:31], a[156:159], v[172:175], v[28:31]
    buffer_load_dwordx4 a[236:239], v5, s[48:51], s95 offen sc1 nt
    s_addk_i32 s95, 0x1000
    v_and_b32 v172, v113, v40
    v_and_b32 v173, v113, v41
    v_and_b32 v174, v113, v42
    v_and_b32 v175, v113, v43
    s_waitcnt vmcnt(19)
    v_mfma_f32_16x16x32_bf16 v[28:31], a[160:163], v[168:171], v[28:31]
    buffer_load_dwordx4 a[240:243], v5, s[48:51], s95 offen sc1 nt
    s_addk_i32 s95, 0x1000
    v_and_b32 v168, v114, v40
    v_and_b32 v169, v114, v41
    v_and_b32 v170, v114, v42
    v_and_b32 v171, v114, v43
    s_waitcnt vmcnt(19)
    v_mfma_f32_16x16x32_bf16 v[28:31], a[164:167], v[172:175], v[28:31]
    buffer_load_dwordx4 a[244:247], v5, s[48:51], s95 offen sc1 nt
    s_addk_i32 s95, 0x1000
    v_and_b32 v172, v115, v40
    v_and_b32 v173, v115, v41
    v_and_b32 v174, v115, v42
    v_and_b32 v175, v115, v43
    s_waitcnt vmcnt(19)
    v_mfma_f32_16x16x32_bf16 v[28:31], a[168:171], v[168:171], v[28:31]
    buffer_load_dwordx4 a[248:251], v5, s[48:51], s95 offen sc1 nt
    s_addk_i32 s95, 0x1000
    v_and_b32 v168, v116, v40
    v_and_b32 v169, v116, v41
    v_and_b32 v170, v116, v42
    v_and_b32 v171, v116, v43
    s_waitcnt vmcnt(19)
    v_mfma_f32_16x16x32_bf16 v[28:31], a[172:175], v[172:175], v[28:31]
    buffer_load_dwordx4 a[252:255], v5, s[48:51], s95 offen sc1 nt
    s_addk_i32 s95, 0x1000
    s_add_u32 s5, s93, 0
    buffer_load_dwordx4 v[176:179], v9, s[52:55], s5 offen sc1
    buffer_load_dwordx4 v[180:183], v9, s[52:55], s5 offen offset:1024 sc1
    s_add_u32 s5, s93, 589824
    buffer_load_dwordx4 v[184:187], v9, s[52:55], s5 offen sc1
    buffer_load_dwordx4 v[188:191], v9, s[52:55], s5 offen offset:1024 sc1
    s_add_u32 s5, s93, 32768
    buffer_load_dwordx4 v[56:59], v9, s[52:55], s5 offen sc1
    buffer_load_dwordx4 v[60:63], v9, s[52:55], s5 offen offset:1024 sc1
    s_add_u32 s5, s93, 622592
    buffer_load_dwordx4 v[64:67], v9, s[52:55], s5 offen sc1
    buffer_load_dwordx4 v[68:71], v9, s[52:55], s5 offen offset:1024 sc1
    v_and_b32 v172, v117, v40
    v_and_b32 v173, v117, v41
    v_and_b32 v174, v117, v42
    v_and_b32 v175, v117, v43
    s_waitcnt vmcnt(27)
    v_mfma_f32_16x16x32_bf16 v[28:31], a[176:179], v[168:171], v[28:31]
    v_and_b32 v168, v118, v40
    v_and_b32 v169, v118, v41
    v_and_b32 v170, v118, v42
    v_and_b32 v171, v118, v43
    s_waitcnt vmcnt(26)
    v_mfma_f32_16x16x32_bf16 v[28:31], a[180:183], v[172:175], v[28:31]
    v_and_b32 v172, v119, v40
    v_and_b32 v173, v119, v41
    v_and_b32 v174, v119, v42
    v_and_b32 v175, v119, v43
    s_waitcnt vmcnt(25)
    v_mfma_f32_16x16x32_bf16 v[28:31], a[184:187], v[168:171], v[28:31]
    v_and_b32 v168, v120, v40
    v_and_b32 v169, v120, v41
    v_and_b32 v170, v120, v42
    v_and_b32 v171, v120, v43
    s_waitcnt vmcnt(24)
    v_mfma_f32_16x16x32_bf16 v[28:31], a[188:191], v[172:175], v[28:31]
    v_and_b32 v172, v121, v40
    v_and_b32 v173, v121, v41
    v_and_b32 v174, v121, v42
    v_and_b32 v175, v121, v43
    s_waitcnt vmcnt(23)
    v_mfma_f32_16x16x32_bf16 v[28:31], a[192:195], v[168:171], v[28:31]
    v_and_b32 v168, v122, v40
    v_and_b32 v169, v122, v41
    v_and_b32 v170, v122, v42
    v_and_b32 v171, v122, v43
    s_waitcnt vmcnt(22)
    v_mfma_f32_16x16x32_bf16 v[28:31], a[196:199], v[172:175], v[28:31]
    v_and_b32 v172, v123, v40
    v_and_b32 v173, v123, v41
    v_and_b32 v174, v123, v42
    v_and_b32 v175, v123, v43
    s_waitcnt vmcnt(21)
    v_mfma_f32_16x16x32_bf16 v[28:31], a[200:203], v[168:171], v[28:31]
    v_and_b32 v168, v124, v40
    v_and_b32 v169, v124, v41
    v_and_b32 v170, v124, v42
    v_and_b32 v171, v124, v43
    s_waitcnt vmcnt(20)
    v_mfma_f32_16x16x32_bf16 v[28:31], a[204:207], v[172:175], v[28:31]
    v_and_b32 v172, v125, v40
    v_and_b32 v173, v125, v41
    v_and_b32 v174, v125, v42
    v_and_b32 v175, v125, v43
    s_waitcnt vmcnt(19)
    v_mfma_f32_16x16x32_bf16 v[28:31], a[208:211], v[168:171], v[28:31]
    v_and_b32 v168, v126, v40
    v_and_b32 v169, v126, v41
    v_and_b32 v170, v126, v42
    v_and_b32 v171, v126, v43
    s_waitcnt vmcnt(18)
    v_mfma_f32_16x16x32_bf16 v[28:31], a[212:215], v[172:175], v[28:31]
    v_and_b32 v172, v127, v40
    v_and_b32 v173, v127, v41
    v_and_b32 v174, v127, v42
    v_and_b32 v175, v127, v43
    s_waitcnt vmcnt(17)
    v_mfma_f32_16x16x32_bf16 v[28:31], a[216:219], v[168:171], v[28:31]
    v_and_b32 v168, v128, v40
    v_and_b32 v169, v128, v41
    v_and_b32 v170, v128, v42
    v_and_b32 v171, v128, v43
    s_waitcnt vmcnt(16)
    v_mfma_f32_16x16x32_bf16 v[28:31], a[220:223], v[172:175], v[28:31]
    v_bfe_u32 v12, v1, 3, 1
    v_mul_u32_u24 v44, 800, v12
    v_mul_u32_u24 v12, 192, v2
    v_add_u32 v44, v44, v12
    v_and_b32 v13, 7, v1
    v_lshl_add_u32 v44, v13, 2, v44
    s_mul_i32 s5, s3, 1600
    s_add_u32 s5, s5, 24576
    v_add_u32 v44, s5, v44
    v_lshrrev_b32 v12, 3, v3
    v_mul_u32_u24 v45, 192, v12
    v_and_b32 v13, 7, v3
    v_lshl_add_u32 v45, v13, 4, v45
    s_lshr_b32 s5, s3, 1
    s_mul_i32 s5, s5, 800
    s_and_b32 s6, s3, 1
    s_mul_i32 s6, s6, 384
    s_add_u32 s5, s5, s6
    s_add_u32 s5, s5, 24576
    v_add_u32 v45, s5, v45
    v_and_b32 v12, 1, v3
    v_lshlrev_b32 v46, 7, v12
    v_lshrrev_b32 v12, 1, v3
    v_lshl_add_u32 v46, v12, 4, v46
    v_and_b32 v12, 7, v1
    v_lshlrev_b32 v12, 4, v12
    v_add_u32 v12, 256, v12
    v_cmp_lt_u32 vcc, 15, v1
    s_lshr_b32 s5, s3, 1
    s_lshl_b32 s5, s5, 3
    v_cndmask_b32 v46, v46, v12, vcc
    v_readlane_b32 s6, v32, s5
    s_nop 1
    v_mov_b32 v34, s6
    v_mul_f32 v34, s15, v34
    v_and_b32 v172, v129, v40
    v_and_b32 v173, v129, v41
    v_and_b32 v174, v129, v42
    v_and_b32 v175, v129, v43
    s_waitcnt vmcnt(15)
    v_mfma_f32_16x16x32_bf16 v[28:31], a[224:227], v[168:171], v[28:31]
    v_and_b32 v168, v130, v40
    v_and_b32 v169, v130, v41
    v_and_b32 v170, v130, v42
    v_and_b32 v171, v130, v43
    s_waitcnt vmcnt(14)
    v_mfma_f32_16x16x32_bf16 v[28:31], a[228:231], v[172:175], v[28:31]
    v_and_b32 v172, v131, v40
    v_and_b32 v173, v131, v41
    v_and_b32 v174, v131, v42
    v_and_b32 v175, v131, v43
    s_waitcnt vmcnt(13)
    v_mfma_f32_16x16x32_bf16 v[28:31], a[232:235], v[168:171], v[28:31]
    v_and_b32 v168, v132, v40
    v_and_b32 v169, v132, v41
    v_and_b32 v170, v132, v42
    v_and_b32 v171, v132, v43
    s_waitcnt vmcnt(12)
    v_mfma_f32_16x16x32_bf16 v[28:31], a[236:239], v[172:175], v[28:31]
    v_and_b32 v172, v133, v40
    v_and_b32 v173, v133, v41
    v_and_b32 v174, v133, v42
    v_and_b32 v175, v133, v43
    s_waitcnt vmcnt(11)
    v_mfma_f32_16x16x32_bf16 v[28:31], a[240:243], v[168:171], v[28:31]
    v_and_b32 v168, v134, v40
    v_and_b32 v169, v134, v41
    v_and_b32 v170, v134, v42
    v_and_b32 v171, v134, v43
    s_waitcnt vmcnt(10)
    v_mfma_f32_16x16x32_bf16 v[28:31], a[244:247], v[172:175], v[28:31]
    v_and_b32 v172, v135, v40
    v_and_b32 v173, v135, v41
    v_and_b32 v174, v135, v42
    v_and_b32 v175, v135, v43
    s_waitcnt vmcnt(9)
    v_mfma_f32_16x16x32_bf16 v[28:31], a[248:251], v[168:171], v[28:31]
    s_nop 1
    s_waitcnt vmcnt(8)
    v_mfma_f32_16x16x32_bf16 v[28:31], a[252:255], v[172:175], v[28:31]
    s_lshr_b32 s5, s3, 1
    s_lshl_b32 s5, s5, 4
    s_add_u32 s6, s5, 19456
    v_mov_b32 v15, s6
    v_mov_b32 v17, v7
    v_mov_b32 v19, v7
    s_nop 2
    ds_write_b32 v44, v28
    ds_write_b32 v44, v29 offset:32
    ds_write_b32 v44, v30 offset:64
    ds_write_b32 v44, v31 offset:96
    s_waitcnt lgkmcnt(0)
    s_barrier

    ds_read_b128 v[88:91], v15 offset:32
    ds_read_b128 v[72:75], v45
    ds_read_b128 v[76:79], v45 offset:1600
    ds_read_b128 v[80:83], v45 offset:3200
    ds_read_b128 v[84:87], v45 offset:4800
    s_waitcnt lgkmcnt(4)
    v_add_f32 v88, v88, v89
    v_add_f32 v90, v90, v91
    s_waitcnt lgkmcnt(2)
    v_add_f32 v72, v72, v76
    v_add_f32 v73, v73, v77
    v_add_f32 v74, v74, v78
    v_add_f32 v75, v75, v79
    v_add_f32 v94, v88, v90
    s_waitcnt lgkmcnt(0)
    v_add_f32 v80, v80, v84
    v_add_f32 v81, v81, v85
    v_add_f32 v82, v82, v86
    v_add_f32 v83, v83, v87
    v_add_f32 v72, v72, v80
    v_add_f32 v73, v73, v81
    v_add_f32 v74, v74, v82
    v_add_f32 v75, v75, v83
    v_cvt_pk_bf16_f32 v16, v72, v73
    v_cvt_pk_bf16_f32 v18, v74, v75
    s_mov_b64 exec, 0xff0000
    v_mov_b32 v16, v34
    v_mov_b32 v18, v94
    s_mov_b64 exec, 0xffffff
    buffer_store_dwordx4 v[16:19], v46, s[52:55], s101 offen sc1
    s_mov_b64 exec, -1
    s_branch L_tail_3
L_seg2_30:
    buffer_load_dwordx4 v[20:23], v10, s[52:55], s92 offen sc1
    buffer_load_dwordx4 v[24:27], v10, s[52:55], s92 offen offset:16 sc1
    s_mov_b32 s95, 0
    buffer_load_dwordx4 a[128:131], v5, s[48:51], s95 offen sc1 nt
    s_addk_i32 s95, 0x1000
    buffer_load_dwordx4 a[132:135], v5, s[48:51], s95 offen sc1 nt
    s_addk_i32 s95, 0x1000
    buffer_load_dwordx4 a[136:139], v5, s[48:51], s95 offen sc1 nt
    s_addk_i32 s95, 0x1000
    buffer_load_dwordx4 a[140:143], v5, s[48:51], s95 offen sc1 nt
    s_addk_i32 s95, 0x1000
    buffer_load_dwordx4 a[144:147], v5, s[48:51], s95 offen sc1 nt
    s_addk_i32 s95, 0x1000
    buffer_load_dwordx4 a[148:151], v5, s[48:51], s95 offen sc1 nt
    s_addk_i32 s95, 0x1000
    buffer_load_dwordx4 a[152:155], v5, s[48:51], s95 offen sc1 nt
    s_addk_i32 s95, 0x1000
    buffer_load_dwordx4 a[156:159], v5, s[48:51], s95 offen sc1 nt
    s_addk_i32 s95, 0x1000
    buffer_load_dwordx4 a[160:163], v5, s[48:51], s95 offen sc1 nt
    s_addk_i32 s95, 0x1000
    buffer_load_dwordx4 a[164:167], v5, s[48:51], s95 offen sc1 nt
    s_addk_i32 s95, 0x1000
    s_waitcnt vmcnt(10)
    v_xor_b32 v12, s84, v21
    v_bitop3_b32 v12, v23, s84, v12 bitop3:0xbe
    v_bitop3_b32 v12, v25, s84, v12 bitop3:0xbe
    v_bitop3_b32 v12, v27, s84, v12 bitop3:0xbe
    v_cmp_ne_u32 vcc, 0, v12
    s_cbranch_vccz L_qok7
    s_mov_b32 s85, 0
L_qspin8:
    buffer_load_dwordx4 v[20:23], v10, s[52:55], s92 offen sc1
    buffer_load_dwordx4 v[24:27], v10, s[52:55], s92 offen offset:16 sc1
    s_waitcnt vmcnt(0)
    v_xor_b32 v12, s84, v21
    v_bitop3_b32 v12, v23, s84, v12 bitop3:0xbe
    v_bitop3_b32 v12, v25, s84, v12 bitop3:0xbe
    v_bitop3_b32 v12, v27, s84, v12 bitop3:0xbe
    v_cmp_ne_u32 vcc, 0, v12
    s_cbranch_vccz L_qok7
    s_add_u32 s85, s85, 1
    s_cmp_gt_u32 s85, 4096
    s_cbranch_scc1 L_qok7
    s_sleep 2
    s_branch L_qspin8
L_qok7:
    v_mov_b32 v21, v22
    v_mov_b32 v22, v24
    v_mov_b32 v23, v26
    s_nop 1
    v_mfma_f32_16x16x32_bf16 v[144:147], a[0:3], v[20:23], 0
    v_mfma_f32_16x16x32_bf16 v[148:151], a[4:7], v[20:23], 0
    v_mfma_f32_16x16x32_bf16 v[152:155], a[8:11], v[20:23], 0
    v_mfma_f32_16x16x32_bf16 v[156:159], a[12:15], v[20:23], 0
    v_mfma_f32_16x16x32_bf16 v[160:163], a[16:19], v[20:23], 0
    v_mfma_f32_16x16x32_bf16 v[164:167], a[20:23], v[20:23], 0
    v_mfma_f32_16x16x32_bf16 v[168:171], a[24:27], v[20:23], 0
    v_mfma_f32_16x16x32_bf16 v[172:175], a[28:31], v[20:23], 0
    s_nop 3
    v_mov_b32_dpp v104, v144 quad_perm:[0,0,0,0] row_mask:0xf bank_mask:0xf
    v_mov_b32_dpp v105, v148 quad_perm:[0,0,0,0] row_mask:0xf bank_mask:0xf
    v_mov_b32_dpp v106, v152 quad_perm:[0,0,0,0] row_mask:0xf bank_mask:0xf
    v_mov_b32_dpp v107, v156 quad_perm:[0,0,0,0] row_mask:0xf bank_mask:0xf
    v_add_f32_dpp v104, v145, v104 quad_perm:[1,1,1,1] row_mask:0xf bank_mask:0xf
    v_add_f32_dpp v105, v149, v105 quad_perm:[1,1,1,1] row_mask:0xf bank_mask:0xf
    v_add_f32_dpp v106, v153, v106 quad_perm:[1,1,1,1] row_mask:0xf bank_mask:0xf
    v_add_f32_dpp v107, v157, v107 quad_perm:[1,1,1,1] row_mask:0xf bank_mask:0xf
    v_add_f32_dpp v104, v146, v104 quad_perm:[2,2,2,2] row_mask:0xf bank_mask:0xf
    v_add_f32_dpp v105, v150, v105 quad_perm:[2,2,2,2] row_mask:0xf bank_mask:0xf
    v_add_f32_dpp v106, v154, v106 quad_perm:[2,2,2,2] row_mask:0xf bank_mask:0xf
    v_add_f32_dpp v107, v158, v107 quad_perm:[2,2,2,2] row_mask:0xf bank_mask:0xf
    v_add_f32_dpp v104, v147, v104 quad_perm:[3,3,3,3] row_mask:0xf bank_mask:0xf
    v_add_f32_dpp v105, v151, v105 quad_perm:[3,3,3,3] row_mask:0xf bank_mask:0xf
    v_add_f32_dpp v106, v155, v106 quad_perm:[3,3,3,3] row_mask:0xf bank_mask:0xf
    v_add_f32_dpp v107, v159, v107 quad_perm:[3,3,3,3] row_mask:0xf bank_mask:0xf
    v_mfma_f32_16x16x32_bf16 v[144:147], a[32:35], v[20:23], 0
    v_mfma_f32_16x16x32_bf16 v[148:151], a[36:39], v[20:23], 0
    v_mfma_f32_16x16x32_bf16 v[152:155], a[40:43], v[20:23], 0
    v_mfma_f32_16x16x32_bf16 v[156:159], a[44:47], v[20:23], 0
    v_mov_b32_dpp v108, v160 quad_perm:[0,0,0,0] row_mask:0xf bank_mask:0xf
    v_mov_b32_dpp v109, v164 quad_perm:[0,0,0,0] row_mask:0xf bank_mask:0xf
    v_mov_b32_dpp v110, v168 quad_perm:[0,0,0,0] row_mask:0xf bank_mask:0xf
    v_mov_b32_dpp v111, v172 quad_perm:[0,0,0,0] row_mask:0xf bank_mask:0xf
    v_add_f32_dpp v108, v161, v108 quad_perm:[1,1,1,1] row_mask:0xf bank_mask:0xf
    v_add_f32_dpp v109, v165, v109 quad_perm:[1,1,1,1] row_mask:0xf bank_mask:0xf
    v_add_f32_dpp v110, v169, v110 quad_perm:[1,1,1,1] row_mask:0xf bank_mask:0xf
    v_add_f32_dpp v111, v173, v111 quad_perm:[1,1,1,1] row_mask:0xf bank_mask:0xf
    v_add_f32_dpp v108, v162, v108 quad_perm:[2,2,2,2] row_mask:0xf bank_mask:0xf
    v_add_f32_dpp v109, v166, v109 quad_perm:[2,2,2,2] row_mask:0xf bank_mask:0xf
    v_add_f32_dpp v110, v170, v110 quad_perm:[2,2,2,2] row_mask:0xf bank_mask:0xf
    v_add_f32_dpp v111, v174, v111 quad_perm:[2,2,2,2] row_mask:0xf bank_mask:0xf
    v_add_f32_dpp v108, v163, v108 quad_perm:[3,3,3,3] row_mask:0xf bank_mask:0xf
    v_add_f32_dpp v109, v167, v109 quad_perm:[3,3,3,3] row_mask:0xf bank_mask:0xf
    v_add_f32_dpp v110, v171, v110 quad_perm:[3,3,3,3] row_mask:0xf bank_mask:0xf
    v_add_f32_dpp v111, v175, v111 quad_perm:[3,3,3,3] row_mask:0xf bank_mask:0xf
    v_mfma_f32_16x16x32_bf16 v[160:163], a[48:51], v[20:23], 0
    v_mfma_f32_16x16x32_bf16 v[164:167], a[52:55], v[20:23], 0
    v_mfma_f32_16x16x32_bf16 v[168:171], a[56:59], v[20:23], 0
    v_mfma_f32_16x16x32_bf16 v[172:175], a[60:63], v[20:23], 0
    buffer_load_dwordx4 a[168:171], v5, s[48:51], s95 offen sc1 nt
    s_addk_i32 s95, 0x1000
    v_mov_b32_dpp v112, v144 quad_perm:[0,0,0,0] row_mask:0xf bank_mask:0xf
    v_mov_b32_dpp v113, v148 quad_perm:[0,0,0,0] row_mask:0xf bank_mask:0xf
    v_mov_b32_dpp v114, v152 quad_perm:[0,0,0,0] row_mask:0xf bank_mask:0xf
    v_mov_b32_dpp v115, v156 quad_perm:[0,0,0,0] row_mask:0xf bank_mask:0xf
    v_add_f32_dpp v112, v145, v112 quad_perm:[1,1,1,1] row_mask:0xf bank_mask:0xf
    v_add_f32_dpp v113, v149, v113 quad_perm:[1,1,1,1] row_mask:0xf bank_mask:0xf
    v_add_f32_dpp v114, v153, v114 quad_perm:[1,1,1,1] row_mask:0xf bank_mask:0xf
    v_add_f32_dpp v115, v157, v115 quad_perm:[1,1,1,1] row_mask:0xf bank_mask:0xf
    v_add_f32_dpp v112, v146, v112 quad_perm:[2,2,2,2] row_mask:0xf bank_mask:0xf
    v_add_f32_dpp v113, v150, v113 quad_perm:[2,2,2,2] row_mask:0xf bank_mask:0xf
    v_add_f32_dpp v114, v154, v114 quad_perm:[2,2,2,2] row_mask:0xf bank_mask:0xf
    v_add_f32_dpp v115, v158, v115 quad_perm:[2,2,2,2] row_mask:0xf bank_mask:0xf
    v_add_f32_dpp v112, v147, v112 quad_perm:[3,3,3,3] row_mask:0xf bank_mask:0xf
    v_add_f32_dpp v113, v151, v113 quad_perm:[3,3,3,3] row_mask:0xf bank_mask:0xf
    v_add_f32_dpp v114, v155, v114 quad_perm:[3,3,3,3] row_mask:0xf bank_mask:0xf
    v_add_f32_dpp v115, v159, v115 quad_perm:[3,3,3,3] row_mask:0xf bank_mask:0xf
    v_mfma_f32_16x16x32_bf16 v[144:147], a[64:67], v[20:23], 0
    v_mfma_f32_16x16x32_bf16 v[148:151], a[68:71], v[20:23], 0
    v_mfma_f32_16x16x32_bf16 v[152:155], a[72:75], v[20:23], 0
    v_mfma_f32_16x16x32_bf16 v[156:159], a[76:79], v[20:23], 0
    v_mov_b32_dpp v116, v160 quad_perm:[0,0,0,0] row_mask:0xf bank_mask:0xf
    v_mov_b32_dpp v117, v164 quad_perm:[0,0,0,0] row_mask:0xf bank_mask:0xf
    v_mov_b32_dpp v118, v168 quad_perm:[0,0,0,0] row_mask:0xf bank_mask:0xf
    v_mov_b32_dpp v119, v172 quad_perm:[0,0,0,0] row_mask:0xf bank_mask:0xf
    v_add_f32_dpp v116, v161, v116 quad_perm:[1,1,1,1] row_mask:0xf bank_mask:0xf
    v_add_f32_dpp v117, v165, v117 quad_perm:[1,1,1,1] row_mask:0xf bank_mask:0xf
    v_add_f32_dpp v118, v169, v118 quad_perm:[1,1,1,1] row_mask:0xf bank_mask:0xf
    v_add_f32_dpp v119, v173, v119 quad_perm:[1,1,1,1] row_mask:0xf bank_mask:0xf
    v_add_f32_dpp v116, v162, v116 quad_perm:[2,2,2,2] row_mask:0xf bank_mask:0xf
    v_add_f32_dpp v117, v166, v117 quad_perm:[2,2,2,2] row_mask:0xf bank_mask:0xf
    v_add_f32_dpp v118, v170, v118 quad_perm:[2,2,2,2] row_mask:0xf bank_mask:0xf
    v_add_f32_dpp v119, v174, v119 quad_perm:[2,2,2,2] row_mask:0xf bank_mask:0xf
    v_add_f32_dpp v116, v163, v116 quad_perm:[3,3,3,3] row_mask:0xf bank_mask:0xf
    v_add_f32_dpp v117, v167, v117 quad_perm:[3,3,3,3] row_mask:0xf bank_mask:0xf
    v_add_f32_dpp v118, v171, v118 quad_perm:[3,3,3,3] row_mask:0xf bank_mask:0xf
    v_add_f32_dpp v119, v175, v119 quad_perm:[3,3,3,3] row_mask:0xf bank_mask:0xf
    v_mfma_f32_16x16x32_bf16 v[160:163], a[80:83], v[20:23], 0
    v_mfma_f32_16x16x32_bf16 v[164:167], a[84:87], v[20:23], 0
    v_mfma_f32_16x16x32_bf16 v[168:171], a[88:91], v[20:23], 0
    v_mfma_f32_16x16x32_bf16 v[172:175], a[92:95], v[20:23], 0
    buffer_load_dwordx4 a[172:175], v5, s[48:51], s95 offen sc1 nt
    s_addk_i32 s95, 0x1000
    v_mov_b32_dpp v120, v144 quad_perm:[0,0,0,0] row_mask:0xf bank_mask:0xf
    v_mov_b32_dpp v121, v148 quad_perm:[0,0,0,0] row_mask:0xf bank_mask:0xf
    v_mov_b32_dpp v122, v152 quad_perm:[0,0,0,0] row_mask:0xf bank_mask:0xf
    v_mov_b32_dpp v123, v156 quad_perm:[0,0,0,0] row_mask:0xf bank_mask:0xf
    v_add_f32_dpp v120, v145, v120 quad_perm:[1,1,1,1] row_mask:0xf bank_mask:0xf
    v_add_f32_dpp v121, v149, v121 quad_perm:[1,1,1,1] row_mask:0xf bank_mask:0xf
    v_add_f32_dpp v122, v153, v122 quad_perm:[1,1,1,1] row_mask:0xf bank_mask:0xf
    v_add_f32_dpp v123, v157, v123 quad_perm:[1,1,1,1] row_mask:0xf bank_mask:0xf
    v_add_f32_dpp v120, v146, v120 quad_perm:[2,2,2,2] row_mask:0xf bank_mask:0xf
    v_add_f32_dpp v121, v150, v121 quad_perm:[2,2,2,2] row_mask:0xf bank_mask:0xf
    v_add_f32_dpp v122, v154, v122 quad_perm:[2,2,2,2] row_mask:0xf bank_mask:0xf
    v_add_f32_dpp v123, v158, v123 quad_perm:[2,2,2,2] row_mask:0xf bank_mask:0xf
    v_add_f32_dpp v120, v147, v120 quad_perm:[3,3,3,3] row_mask:0xf bank_mask:0xf
    v_add_f32_dpp v121, v151, v121 quad_perm:[3,3,3,3] row_mask:0xf bank_mask:0xf
    v_add_f32_dpp v122, v155, v122 quad_perm:[3,3,3,3] row_mask:0xf bank_mask:0xf
    v_add_f32_dpp v123, v159, v123 quad_perm:[3,3,3,3] row_mask:0xf bank_mask:0xf
    v_mfma_f32_16x16x32_bf16 v[144:147], a[96:99], v[20:23], 0
    v_mfma_f32_16x16x32_bf16 v[148:151], a[100:103], v[20:23], 0
    v_mfma_f32_16x16x32_bf16 v[152:155], a[104:107], v[20:23], 0
    v_mfma_f32_16x16x32_bf16 v[156:159], a[108:111], v[20:23], 0
    v_mov_b32_dpp v124, v160 quad_perm:[0,0,0,0] row_mask:0xf bank_mask:0xf
    v_mov_b32_dpp v125, v164 quad_perm:[0,0,0,0] row_mask:0xf bank_mask:0xf
    v_mov_b32_dpp v126, v168 quad_perm:[0,0,0,0] row_mask:0xf bank_mask:0xf
    v_mov_b32_dpp v127, v172 quad_perm:[0,0,0,0] row_mask:0xf bank_mask:0xf
    v_add_f32_dpp v124, v161, v124 quad_perm:[1,1,1,1] row_mask:0xf bank_mask:0xf
    v_add_f32_dpp v125, v165, v125 quad_perm:[1,1,1,1] row_mask:0xf bank_mask:0xf
    v_add_f32_dpp v126, v169, v126 quad_perm:[1,1,1,1] row_mask:0xf bank_mask:0xf
    v_add_f32_dpp v127, v173, v127 quad_perm:[1,1,1,1] row_mask:0xf bank_mask:0xf
    v_add_f32_dpp v124, v162, v124 quad_perm:[2,2,2,2] row_mask:0xf bank_mask:0xf
    v_add_f32_dpp v125, v166, v125 quad_perm:[2,2,2,2] row_mask:0xf bank_mask:0xf
    v_add_f32_dpp v126, v170, v126 quad_perm:[2,2,2,2] row_mask:0xf bank_mask:0xf
    v_add_f32_dpp v127, v174, v127 quad_perm:[2,2,2,2] row_mask:0xf bank_mask:0xf
    v_add_f32_dpp v124, v163, v124 quad_perm:[3,3,3,3] row_mask:0xf bank_mask:0xf
    v_add_f32_dpp v125, v167, v125 quad_perm:[3,3,3,3] row_mask:0xf bank_mask:0xf
    v_add_f32_dpp v126, v171, v126 quad_perm:[3,3,3,3] row_mask:0xf bank_mask:0xf
    v_add_f32_dpp v127, v175, v127 quad_perm:[3,3,3,3] row_mask:0xf bank_mask:0xf
    v_mfma_f32_16x16x32_bf16 v[160:163], a[112:115], v[20:23], 0
    v_mfma_f32_16x16x32_bf16 v[164:167], a[116:119], v[20:23], 0
    buffer_load_dwordx4 a[176:179], v5, s[48:51], s95 offen sc1 nt
    s_addk_i32 s95, 0x1000
    v_mov_b32_dpp v128, v144 quad_perm:[0,0,0,0] row_mask:0xf bank_mask:0xf
    v_mov_b32_dpp v129, v148 quad_perm:[0,0,0,0] row_mask:0xf bank_mask:0xf
    v_mov_b32_dpp v130, v152 quad_perm:[0,0,0,0] row_mask:0xf bank_mask:0xf
    v_mov_b32_dpp v131, v156 quad_perm:[0,0,0,0] row_mask:0xf bank_mask:0xf
    v_add_f32_dpp v128, v145, v128 quad_perm:[1,1,1,1] row_mask:0xf bank_mask:0xf
    v_add_f32_dpp v129, v149, v129 quad_perm:[1,1,1,1] row_mask:0xf bank_mask:0xf
    v_add_f32_dpp v130, v153, v130 quad_perm:[1,1,1,1] row_mask:0xf bank_mask:0xf
    v_add_f32_dpp v131, v157, v131 quad_perm:[1,1,1,1] row_mask:0xf bank_mask:0xf
    v_add_f32_dpp v128, v146, v128 quad_perm:[2,2,2,2] row_mask:0xf bank_mask:0xf
    v_add_f32_dpp v129, v150, v129 quad_perm:[2,2,2,2] row_mask:0xf bank_mask:0xf
    v_add_f32_dpp v130, v154, v130 quad_perm:[2,2,2,2] row_mask:0xf bank_mask:0xf
    v_add_f32_dpp v131, v158, v131 quad_perm:[2,2,2,2] row_mask:0xf bank_mask:0xf
    v_add_f32_dpp v128, v147, v128 quad_perm:[3,3,3,3] row_mask:0xf bank_mask:0xf
    v_add_f32_dpp v129, v151, v129 quad_perm:[3,3,3,3] row_mask:0xf bank_mask:0xf
    v_add_f32_dpp v130, v155, v130 quad_perm:[3,3,3,3] row_mask:0xf bank_mask:0xf
    v_add_f32_dpp v131, v159, v131 quad_perm:[3,3,3,3] row_mask:0xf bank_mask:0xf
    v_mov_b32_dpp v132, v160 quad_perm:[0,0,0,0] row_mask:0xf bank_mask:0xf
    v_mov_b32_dpp v133, v164 quad_perm:[0,0,0,0] row_mask:0xf bank_mask:0xf
    s_nop 0
    v_add_f32_dpp v132, v161, v132 quad_perm:[1,1,1,1] row_mask:0xf bank_mask:0xf
    v_add_f32_dpp v133, v165, v133 quad_perm:[1,1,1,1] row_mask:0xf bank_mask:0xf
    s_nop 0
    v_add_f32_dpp v132, v162, v132 quad_perm:[2,2,2,2] row_mask:0xf bank_mask:0xf
    v_add_f32_dpp v133, v166, v133 quad_perm:[2,2,2,2] row_mask:0xf bank_mask:0xf
    s_nop 0
    v_add_f32_dpp v132, v163, v132 quad_perm:[3,3,3,3] row_mask:0xf bank_mask:0xf
    v_add_f32_dpp v133, v167, v133 quad_perm:[3,3,3,3] row_mask:0xf bank_mask:0xf
    buffer_load_dwordx4 a[180:183], v5, s[48:51], s95 offen sc1 nt
    s_addk_i32 s95, 0x1000
    v_max3_f32 v32, v104, v105, v106
    v_max3_f32 v32, v32, v107, v108
    v_max3_f32 v32, v32, v109, v110
    v_max3_f32 v32, v32, v111, v112
    v_max3_f32 v32, v32, v113, v114
    v_max3_f32 v32, v32, v115, v116
    v_max3_f32 v32, v32, v117, v118
    v_max3_f32 v32, v32, v119, v120
    v_max3_f32 v32, v32, v121, v122
    v_max3_f32 v32, v32, v123, v124
    v_max3_f32 v32, v32, v125, v126
    v_max3_f32 v32, v32, v127, v128
    v_max3_f32 v32, v32, v129, v130
    v_max3_f32 v32, v32, v131, v132
    v_max_f32 v32, v32, v133
    v_mov_b32 v12, v32
    s_nop 1
    v_permlane32_swap_b32 v32, v12
    s_nop 1
    v_max_f32 v32, v32, v12
    v_mov_b32 v12, v32
    s_nop 1
    v_permlane16_swap_b32 v32, v12
    s_nop 1
    v_max_f32 v32, v32, v12
    v_bfe_u32 v13, v1, 3, 1
    v_lshlrev_b32 v13, 4, v13
    s_lshl_b32 s5, s3, 2
    s_add_u32 s5, s5, 19456
    v_add_u32 v14, s5, v13
    v_add_u32 v15, 19456, v13
    s_mov_b64 exec, 0x101
    ds_write_b32 v14, v32
    s_mov_b64 exec, -1
    s_waitcnt lgkmcnt(0)
    s_barrier
    ds_read_b128 v[16:19], v15
    buffer_load_dwordx4 a[184:187], v5, s[48:51], s95 offen sc1 nt
    s_addk_i32 s95, 0x1000
    s_waitcnt lgkmcnt(0)
    v_max3_f32 v32, v16, v17, v18
    v_max_f32 v32, v32, v19
    v_mul_f32 v34, s15, v32
    v_mov_b32 v33, 0
    v_fma_f32 v104, v104, s15, -v34
    v_fma_f32 v105, v105, s15, -v34
    v_fma_f32 v106, v106, s15, -v34
    v_fma_f32 v107, v107, s15, -v34
    v_exp_f32 v104, v104
    v_exp_f32 v105, v105
    v_exp_f32 v106, v106
    v_exp_f32 v107, v107
    v_add_f32 v33, v33, v104
    v_add_f32 v33, v33, v105
    v_add_f32 v33, v33, v106
    v_add_f32 v33, v33, v107
    v_cvt_pk_bf16_f32 v104, v104, v104
    v_cvt_pk_bf16_f32 v105, v105, v105
    v_cvt_pk_bf16_f32 v106, v106, v106
    v_cvt_pk_bf16_f32 v107, v107, v107
    v_fma_f32 v108, v108, s15, -v34
    v_fma_f32 v109, v109, s15, -v34
    v_fma_f32 v110, v110, s15, -v34
    v_fma_f32 v111, v111, s15, -v34
    v_exp_f32 v108, v108
    v_exp_f32 v109, v109
    v_exp_f32 v110, v110
    v_exp_f32 v111, v111
    v_add_f32 v33, v33, v108
    v_add_f32 v33, v33, v109
    v_add_f32 v33, v33, v110
    v_add_f32 v33, v33, v111
    v_cvt_pk_bf16_f32 v108, v108, v108
    v_cvt_pk_bf16_f32 v109, v109, v109
    v_cvt_pk_bf16_f32 v110, v110, v110
    v_cvt_pk_bf16_f32 v111, v111, v111
    buffer_load_dwordx4 a[188:191], v5, s[48:51], s95 offen sc1 nt
    s_addk_i32 s95, 0x1000
    v_fma_f32 v112, v112, s15, -v34
    v_fma_f32 v113, v113, s15, -v34
    v_fma_f32 v114, v114, s15, -v34
    v_fma_f32 v115, v115, s15, -v34
    v_exp_f32 v112, v112
    v_exp_f32 v113, v113
    v_exp_f32 v114, v114
    v_exp_f32 v115, v115
    v_add_f32 v33, v33, v112
    v_add_f32 v33, v33, v113
    v_add_f32 v33, v33, v114
    v_add_f32 v33, v33, v115
    v_cvt_pk_bf16_f32 v112, v112, v112
    v_cvt_pk_bf16_f32 v113, v113, v113
    v_cvt_pk_bf16_f32 v114, v114, v114
    v_cvt_pk_bf16_f32 v115, v115, v115
    v_fma_f32 v116, v116, s15, -v34
    v_fma_f32 v117, v117, s15, -v34
    v_fma_f32 v118, v118, s15, -v34
    v_fma_f32 v119, v119, s15, -v34
    v_exp_f32 v116, v116
    v_exp_f32 v117, v117
    v_exp_f32 v118, v118
    v_exp_f32 v119, v119
    v_add_f32 v33, v33, v116
    v_add_f32 v33, v33, v117
    v_add_f32 v33, v33, v118
    v_add_f32 v33, v33, v119
    v_cvt_pk_bf16_f32 v116, v116, v116
    v_cvt_pk_bf16_f32 v117, v117, v117
    v_cvt_pk_bf16_f32 v118, v118, v118
    v_cvt_pk_bf16_f32 v119, v119, v119
    buffer_load_dwordx4 a[192:195], v5, s[48:51], s95 offen sc1 nt
    s_addk_i32 s95, 0x1000
    v_fma_f32 v120, v120, s15, -v34
    v_fma_f32 v121, v121, s15, -v34
    v_fma_f32 v122, v122, s15, -v34
    v_fma_f32 v123, v123, s15, -v34
    v_exp_f32 v120, v120
    v_exp_f32 v121, v121
    v_exp_f32 v122, v122
    v_exp_f32 v123, v123
    v_add_f32 v33, v33, v120
    v_add_f32 v33, v33, v121
    v_add_f32 v33, v33, v122
    v_add_f32 v33, v33, v123
    v_cvt_pk_bf16_f32 v120, v120, v120
    v_cvt_pk_bf16_f32 v121, v121, v121
    v_cvt_pk_bf16_f32 v122, v122, v122
    v_cvt_pk_bf16_f32 v123, v123, v123
    v_fma_f32 v124, v124, s15, -v34
    v_fma_f32 v125, v125, s15, -v34
    v_fma_f32 v126, v126, s15, -v34
    v_fma_f32 v127, v127, s15, -v34
    v_exp_f32 v124, v124
    v_exp_f32 v125, v125
    v_exp_f32 v126, v126
    v_exp_f32 v127, v127
    v_add_f32 v33, v33, v124
    v_add_f32 v33, v33, v125
    v_add_f32 v33, v33, v126
    v_add_f32 v33, v33, v127
    v_cvt_pk_bf16_f32 v124, v124, v124
    v_cvt_pk_bf16_f32 v125, v125, v125
    v_cvt_pk_bf16_f32 v126, v126, v126
    v_cvt_pk_bf16_f32 v127, v127, v127
    buffer_load_dwordx4 a[196:199], v5, s[48:51], s95 offen sc1 nt
    s_addk_i32 s95, 0x1000
    v_fma_f32 v128, v128, s15, -v34
    v_fma_f32 v129, v129, s15, -v34
    v_fma_f32 v130, v130, s15, -v34
    v_fma_f32 v131, v131, s15, -v34
    v_exp_f32 v128, v128
    v_exp_f32 v129, v129
    v_exp_f32 v130, v130
    v_exp_f32 v131, v131
    v_add_f32 v33, v33, v128
    v_add_f32 v33, v33, v129
    v_add_f32 v33, v33, v130
    v_add_f32 v33, v33, v131
    v_cvt_pk_bf16_f32 v128, v128, v128
    v_cvt_pk_bf16_f32 v129, v129, v129
    v_cvt_pk_bf16_f32 v130, v130, v130
    v_cvt_pk_bf16_f32 v131, v131, v131
    v_fma_f32 v132, v132, s15, -v34
    v_fma_f32 v133, v133, s15, -v34
    v_exp_f32 v132, v132
    v_exp_f32 v133, v133
    s_nop 1
    v_add_f32 v33, v33, v132
    v_add_f32 v33, v33, v133
    v_cvt_pk_bf16_f32 v132, v132, v132
    v_cvt_pk_bf16_f32 v133, v133, v133
    buffer_load_dwordx4 a[200:203], v5, s[48:51], s95 offen sc1 nt
    s_addk_i32 s95, 0x1000
    v_mov_b32 v12, v33
    s_nop 1
    v_permlane32_swap_b32 v33, v12
    s_nop 1
    v_add_f32 v33, v33, v12
    v_mov_b32 v12, v33
    s_nop 1
    v_permlane16_swap_b32 v33, v12
    s_nop 1
    v_add_f32 v33, v33, v12
    s_mov_b64 exec, 0x101
    ds_write_b32 v14, v33 offset:32
    s_mov_b64 exec, -1
    v_mov_b32 v28, 0
    v_mov_b32 v29, 0
    v_mov_b32 v30, 0
    v_mov_b32 v31, 0
L_pv_30_0:
    v_and_b32 v168, v104, v40
    v_and_b32 v169, v104, v41
    v_and_b32 v170, v104, v42
    v_and_b32 v171, v104, v43
    buffer_load_dwordx4 a[204:207], v5, s[48:51], s95 offen sc1 nt
    s_addk_i32 s95, 0x1000
    v_and_b32 v172, v105, v40
    v_and_b32 v173, v105, v41
    v_and_b32 v174, v105, v42
    v_and_b32 v175, v105, v43
    s_waitcnt vmcnt(19)
    v_mfma_f32_16x16x32_bf16 v[28:31], a[128:131], v[168:171], v[28:31]
    buffer_load_dwordx4 a[208:211], v5, s[48:51], s95 offen sc1 nt
    s_addk_i32 s95, 0x1000
    v_and_b32 v168, v106, v40
    v_and_b32 v169, v106, v41
    v_and_b32 v170, v106, v42
    v_and_b32 v171, v106, v43
    s_waitcnt vmcnt(19)
    v_mfma_f32_16x16x32_bf16 v[28:31], a[132:135], v[172:175], v[28:31]
    buffer_load_dwordx4 a[212:215], v5, s[48:51], s95 offen sc1 nt
    s_addk_i32 s95, 0x1000
    v_and_b32 v172, v107, v40
    v_and_b32 v173, v107, v41
    v_and_b32 v174, v107, v42
    v_and_b32 v175, v107, v43
    s_waitcnt vmcnt(19)
    v_mfma_f32_16x16x32_bf16 v[28:31], a[136:139], v[168:171], v[28:31]
    buffer_load_dwordx4 a[216:219], v5, s[48:51], s95 offen sc1 nt
    s_addk_i32 s95, 0x1000
    v_and_b32 v168, v108, v40
    v_and_b32 v169, v108, v41
    v_and_b32 v170, v108, v42
    v_and_b32 v171, v108, v43
    s_waitcnt vmcnt(19)
    v_mfma_f32_16x16x32_bf16 v[28:31], a[140:143], v[172:175], v[28:31]
    buffer_load_dwordx4 a[220:223], v5, s[48:51], s95 offen sc1 nt
    s_addk_i32 s95, 0x1000
    v_and_b32 v172, v109, v40
    v_and_b32 v173, v109, v41
    v_and_b32 v174, v109, v42
    v_and_b32 v175, v109, v43
    s_waitcnt vmcnt(19)
    v_mfma_f32_16x16x32_bf16 v[28:31], a[144:147], v[168:171], v[28:31]
    s_cmp_eq_u32 s3, 0
    s_cbranch_scc0 L_noclaim9
    s_mov_b64 exec, 1
    buffer_atomic_add v37, off, s[52:55], s42 sc0
    s_mov_b64 exec, -1
L_noclaim9:
    buffer_load_dwordx4 a[224:227], v5, s[48:51], s95 offen sc1 nt
    s_addk_i32 s95, 0x1000
    v_and_b32 v168, v110, v40
    v_and_b32 v169, v110, v41
    v_and_b32 v170, v110, v42
    v_and_b32 v171, v110, v43
    s_waitcnt vmcnt(19)
    v_mfma_f32_16x16x32_bf16 v[28:31], a[148:151], v[172:175], v[28:31]
    buffer_load_dwordx4 a[228:231], v5, s[48:51], s95 offen sc1 nt
    s_addk_i32 s95, 0x1000
    v_and_b32 v172, v111, v40
    v_and_b32 v173, v111, v41
    v_and_b32 v174, v111, v42
    v_and_b32 v175, v111, v43
    s_waitcnt vmcnt(19)
    v_mfma_f32_16x16x32_bf16 v[28:31], a[152:155], v[168:171], v[28:31]
    buffer_load_dwordx4 a[232:235], v5, s[48:51], s95 offen sc1 nt
    s_addk_i32 s95, 0x1000
    v_and_b32 v168, v112, v40
    v_and_b32 v169, v112, v41
    v_and_b32 v170, v112, v42
    v_and_b32 v171, v112, v43
    s_waitcnt vmcnt(19)
    v_mfma_f32_16x16x32_bf16 v[28:31], a[156:159], v[172:175], v[28:31]
    buffer_load_dwordx4 a[236:239], v5, s[48:51], s95 offen sc1 nt
    s_addk_i32 s95, 0x1000
    v_and_b32 v172, v113, v40
    v_and_b32 v173, v113, v41
    v_and_b32 v174, v113, v42
    v_and_b32 v175, v113, v43
    s_waitcnt vmcnt(19)
    v_mfma_f32_16x16x32_bf16 v[28:31], a[160:163], v[168:171], v[28:31]
    buffer_load_dwordx4 a[240:243], v5, s[48:51], s95 offen sc1 nt
    s_addk_i32 s95, 0x1000
    v_and_b32 v168, v114, v40
    v_and_b32 v169, v114, v41
    v_and_b32 v170, v114, v42
    v_and_b32 v171, v114, v43
    s_waitcnt vmcnt(19)
    v_mfma_f32_16x16x32_bf16 v[28:31], a[164:167], v[172:175], v[28:31]
    buffer_load_dwordx4 a[244:247], v5, s[48:51], s95 offen sc1 nt
    s_addk_i32 s95, 0x1000
    v_and_b32 v172, v115, v40
    v_and_b32 v173, v115, v41
    v_and_b32 v174, v115, v42
    v_and_b32 v175, v115, v43
    s_waitcnt vmcnt(19)
    v_mfma_f32_16x16x32_bf16 v[28:31], a[168:171], v[168:171], v[28:31]
    v_and_b32 v168, v116, v40
    v_and_b32 v169, v116, v41
    v_and_b32 v170, v116, v42
    v_and_b32 v171, v116, v43
    s_waitcnt vmcnt(18)
    v_mfma_f32_16x16x32_bf16 v[28:31], a[172:175], v[172:175], v[28:31]
    v_and_b32 v172, v117, v40
    v_and_b32 v173, v117, v41
    v_and_b32 v174, v117, v42
    v_and_b32 v175, v117, v43
    s_waitcnt vmcnt(17)
    v_mfma_f32_16x16x32_bf16 v[28:31], a[176:179], v[168:171], v[28:31]
    v_and_b32 v168, v118, v40
    v_and_b32 v169, v118, v41
    v_and_b32 v170, v118, v42
    v_and_b32 v171, v118, v43
    s_waitcnt vmcnt(16)
    v_mfma_f32_16x16x32_bf16 v[28:31], a[180:183], v[172:175], v[28:31]
    v_and_b32 v172, v119, v40
    v_and_b32 v173, v119, v41
    v_and_b32 v174, v119, v42
    v_and_b32 v175, v119, v43
    s_waitcnt vmcnt(15)
    v_mfma_f32_16x16x32_bf16 v[28:31], a[184:187], v[168:171], v[28:31]
    v_and_b32 v168, v120, v40
    v_and_b32 v169, v120, v41
    v_and_b32 v170, v120, v42
    v_and_b32 v171, v120, v43
    s_waitcnt vmcnt(14)
    v_mfma_f32_16x16x32_bf16 v[28:31], a[188:191], v[172:175], v[28:31]
    v_and_b32 v172, v121, v40
    v_and_b32 v173, v121, v41
    v_and_b32 v174, v121, v42
    v_and_b32 v175, v121, v43
    s_waitcnt vmcnt(13)
    v_mfma_f32_16x16x32_bf16 v[28:31], a[192:195], v[168:171], v[28:31]
    v_and_b32 v168, v122, v40
    v_and_b32 v169, v122, v41
    v_and_b32 v170, v122, v42
    v_and_b32 v171, v122, v43
    s_waitcnt vmcnt(12)
    v_mfma_f32_16x16x32_bf16 v[28:31], a[196:199], v[172:175], v[28:31]
    v_and_b32 v172, v123, v40
    v_and_b32 v173, v123, v41
    v_and_b32 v174, v123, v42
    v_and_b32 v175, v123, v43
    s_waitcnt vmcnt(11)
    v_mfma_f32_16x16x32_bf16 v[28:31], a[200:203], v[168:171], v[28:31]
    v_and_b32 v168, v124, v40
    v_and_b32 v169, v124, v41
    v_and_b32 v170, v124, v42
    v_and_b32 v171, v124, v43
    s_waitcnt vmcnt(10)
    v_mfma_f32_16x16x32_bf16 v[28:31], a[204:207], v[172:175], v[28:31]
    v_and_b32 v172, v125, v40
    v_and_b32 v173, v125, v41
    v_and_b32 v174, v125, v42
    v_and_b32 v175, v125, v43
    s_waitcnt vmcnt(9)
    v_mfma_f32_16x16x32_bf16 v[28:31], a[208:211], v[168:171], v[28:31]
    v_and_b32 v168, v126, v40
    v_and_b32 v169, v126, v41
    v_and_b32 v170, v126, v42
    v_and_b32 v171, v126, v43
    s_waitcnt vmcnt(8)
    v_mfma_f32_16x16x32_bf16 v[28:31], a[212:215], v[172:175], v[28:31]
    v_bfe_u32 v12, v1, 3, 1
    v_mul_u32_u24 v44, 800, v12
    v_mul_u32_u24 v12, 192, v2
    v_add_u32 v44, v44, v12
    v_and_b32 v13, 7, v1
    v_lshl_add_u32 v44, v13, 2, v44
    s_mul_i32 s5, s3, 1600
    s_add_u32 s5, s5, 24576
    v_add_u32 v44, s5, v44
    v_lshrrev_b32 v12, 3, v3
    v_mul_u32_u24 v45, 192, v12
    v_and_b32 v13, 7, v3
    v_lshl_add_u32 v45, v13, 4, v45
    s_lshr_b32 s5, s3, 1
    s_mul_i32 s5, s5, 800
    s_and_b32 s6, s3, 1
    s_mul_i32 s6, s6, 384
    s_add_u32 s5, s5, s6
    s_add_u32 s5, s5, 24576
    v_add_u32 v45, s5, v45
    v_and_b32 v12, 1, v3
    v_lshlrev_b32 v46, 7, v12
    v_lshrrev_b32 v12, 1, v3
    v_lshl_add_u32 v46, v12, 4, v46
    v_and_b32 v12, 7, v1
    v_lshlrev_b32 v12, 4, v12
    v_add_u32 v12, 256, v12
    v_cmp_lt_u32 vcc, 15, v1
    s_lshr_b32 s5, s3, 1
    s_lshl_b32 s5, s5, 3
    v_cndmask_b32 v46, v46, v12, vcc
    v_readlane_b32 s6, v32, s5
    s_nop 1
    v_mov_b32 v34, s6
    v_mul_f32 v34, s15, v34
    v_and_b32 v172, v127, v40
    v_and_b32 v173, v127, v41
    v_and_b32 v174, v127, v42
    v_and_b32 v175, v127, v43
    s_waitcnt vmcnt(7)
    v_mfma_f32_16x16x32_bf16 v[28:31], a[216:219], v[168:171], v[28:31]
    v_and_b32 v168, v128, v40
    v_and_b32 v169, v128, v41
    v_and_b32 v170, v128, v42
    v_and_b32 v171, v128, v43
    s_waitcnt vmcnt(6)
    v_mfma_f32_16x16x32_bf16 v[28:31], a[220:223], v[172:175], v[28:31]
    v_and_b32 v172, v129, v40
    v_and_b32 v173, v129, v41
    v_and_b32 v174, v129, v42
    v_and_b32 v175, v129, v43
    s_waitcnt vmcnt(5)
    v_mfma_f32_16x16x32_bf16 v[28:31], a[224:227], v[168:171], v[28:31]
    v_and_b32 v168, v130, v40
    v_and_b32 v169, v130, v41
    v_and_b32 v170, v130, v42
    v_and_b32 v171, v130, v43
    s_waitcnt vmcnt(4)
    v_mfma_f32_16x16x32_bf16 v[28:31], a[228:231], v[172:175], v[28:31]
    v_and_b32 v172, v131, v40
    v_and_b32 v173, v131, v41
    v_and_b32 v174, v131, v42
    v_and_b32 v175, v131, v43
    s_waitcnt vmcnt(3)
    v_mfma_f32_16x16x32_bf16 v[28:31], a[232:235], v[168:171], v[28:31]
    v_and_b32 v168, v132, v40
    v_and_b32 v169, v132, v41
    v_and_b32 v170, v132, v42
    v_and_b32 v171, v132, v43
    s_waitcnt vmcnt(2)
    v_mfma_f32_16x16x32_bf16 v[28:31], a[236:239], v[172:175], v[28:31]
    v_and_b32 v172, v133, v40
    v_and_b32 v173, v133, v41
    v_and_b32 v174, v133, v42
    v_and_b32 v175, v133, v43
    s_waitcnt vmcnt(1)
    v_mfma_f32_16x16x32_bf16 v[28:31], a[240:243], v[168:171], v[28:31]
    s_nop 1
    s_waitcnt vmcnt(0)
    v_mfma_f32_16x16x32_bf16 v[28:31], a[244:247], v[172:175], v[28:31]
    v_mov_b32 v13, 19584
    s_cmp_eq_u32 s3, 0
    s_cbranch_scc0 L_norank10
    s_waitcnt vmcnt(0)
    s_mov_b64 exec, 1
    ds_write_b32 v13, v37
    s_mov_b64 exec, -1
L_norank10:
    s_lshr_b32 s5, s3, 1
    s_lshl_b32 s5, s5, 4
    s_add_u32 s6, s5, 19456
    v_mov_b32 v15, s6
    v_mov_b32 v17, v7
    v_mov_b32 v19, v7
    s_nop 2
    ds_write_b32 v44, v28
    ds_write_b32 v44, v29 offset:32
    ds_write_b32 v44, v30 offset:64
    ds_write_b32 v44, v31 offset:96
    s_waitcnt lgkmcnt(0)
    s_barrier
    ds_read_b32 v37, v13
    ds_read_b128 v[88:91], v15 offset:32
    ds_read_b128 v[72:75], v45
    ds_read_b128 v[76:79], v45 offset:1600
    ds_read_b128 v[80:83], v45 offset:3200
    ds_read_b128 v[84:87], v45 offset:4800
    s_waitcnt lgkmcnt(4)
    v_add_f32 v88, v88, v89
    v_add_f32 v90, v90, v91
    s_waitcnt lgkmcnt(2)
    v_add_f32 v72, v72, v76
    v_add_f32 v73, v73, v77
    v_add_f32 v74, v74, v78
    v_add_f32 v75, v75, v79
    v_add_f32 v94, v88, v90
    s_waitcnt lgkmcnt(0)
    v_add_f32 v80, v80, v84
    v_add_f32 v81, v81, v85
    v_add_f32 v82, v82, v86
    v_add_f32 v83, v83, v87
    v_add_f32 v72, v72, v80
    v_add_f32 v73, v73, v81
    v_add_f32 v74, v74, v82
    v_add_f32 v75, v75, v83
    v_cvt_pk_bf16_f32 v16, v72, v73
    v_cvt_pk_bf16_f32 v18, v74, v75
    s_mov_b64 exec, 0xff0000
    v_mov_b32 v16, v34
    v_mov_b32 v18, v94
    s_mov_b64 exec, 0xffffff
    buffer_store_dwordx4 v[16:19], v46, s[52:55], s101 offen sc1
    s_mov_b64 exec, -1
    s_branch L_tail_0
L_seg2_34:
    buffer_load_dwordx4 v[20:23], v10, s[52:55], s92 offen sc1
    buffer_load_dwordx4 v[24:27], v10, s[52:55], s92 offen offset:16 sc1
    s_mov_b32 s95, 0
    buffer_load_dwordx4 a[136:139], v5, s[48:51], s95 offen sc1 nt
    s_addk_i32 s95, 0x1000
    buffer_load_dwordx4 a[140:143], v5, s[48:51], s95 offen sc1 nt
    s_addk_i32 s95, 0x1000
    buffer_load_dwordx4 a[144:147], v5, s[48:51], s95 offen sc1 nt
    s_addk_i32 s95, 0x1000
    buffer_load_dwordx4 a[148:151], v5, s[48:51], s95 offen sc1 nt
    s_addk_i32 s95, 0x1000
    buffer_load_dwordx4 a[152:155], v5, s[48:51], s95 offen sc1 nt
    s_addk_i32 s95, 0x1000
    buffer_load_dwordx4 a[156:159], v5, s[48:51], s95 offen sc1 nt
    s_addk_i32 s95, 0x1000
    buffer_load_dwordx4 a[160:163], v5, s[48:51], s95 offen sc1 nt
    s_addk_i32 s95, 0x1000
    buffer_load_dwordx4 a[164:167], v5, s[48:51], s95 offen sc1 nt
    s_addk_i32 s95, 0x1000
    buffer_load_dwordx4 a[168:171], v5, s[48:51], s95 offen sc1 nt
    s_addk_i32 s95, 0x1000
    buffer_load_dwordx4 a[172:175], v5, s[48:51], s95 offen sc1 nt
    s_addk_i32 s95, 0x1000
    s_waitcnt vmcnt(10)
    v_xor_b32 v12, s84, v21
    v_bitop3_b32 v12, v23, s84, v12 bitop3:0xbe
    v_bitop3_b32 v12, v25, s84, v12 bitop3:0xbe
    v_bitop3_b32 v12, v27, s84, v12 bitop3:0xbe
    v_cmp_ne_u32 vcc, 0, v12
    s_cbranch_vccz L_qok12
    s_mov_b32 s85, 0
L_qspin13:
    buffer_load_dwordx4 v[20:23], v10, s[52:55], s92 offen sc1
    buffer_load_dwordx4 v[24:27], v10, s[52:55], s92 offen offset:16 sc1
    s_waitcnt vmcnt(0)
    v_xor_b32 v12, s84, v21
    v_bitop3_b32 v12, v23, s84, v12 bitop3:0xbe
    v_bitop3_b32 v12, v25, s84, v12 bitop3:0xbe
    v_bitop3_b32 v12, v27, s84, v12 bitop3:0xbe
    v_cmp_ne_u32 vcc, 0, v12
    s_cbranch_vccz L_qok12
    s_add_u32 s85, s85, 1
    s_cmp_gt_u32 s85, 4096
    s_cbranch_scc1 L_qok12
    s_sleep 2
    s_branch L_qspin13
L_qok12:
    v_mov_b32 v21, v22
    v_mov_b32 v22, v24
    v_mov_b32 v23, v26
    s_nop 1
    v_mfma_f32_16x16x32_bf16 v[144:147], a[0:3], v[20:23], 0
    v_mfma_f32_16x16x32_bf16 v[148:151], a[4:7], v[20:23], 0
    v_mfma_f32_16x16x32_bf16 v[152:155], a[8:11], v[20:23], 0
    v_mfma_f32_16x16x32_bf16 v[156:159], a[12:15], v[20:23], 0
    v_mfma_f32_16x16x32_bf16 v[160:163], a[16:19], v[20:23], 0
    v_mfma_f32_16x16x32_bf16 v[164:167], a[20:23], v[20:23], 0
    v_mfma_f32_16x16x32_bf16 v[168:171], a[24:27], v[20:23], 0
    v_mfma_f32_16x16x32_bf16 v[172:175], a[28:31], v[20:23], 0
    s_nop 3
    v_mov_b32_dpp v104, v144 quad_perm:[0,0,0,0] row_mask:0xf bank_mask:0xf
    v_mov_b32_dpp v105, v148 quad_perm:[0,0,0,0] row_mask:0xf bank_mask:0xf
    v_mov_b32_dpp v106, v152 quad_perm:[0,0,0,0] row_mask:0xf bank_mask:0xf
    v_mov_b32_dpp v107, v156 quad_perm:[0,0,0,0] row_mask:0xf bank_mask:0xf
    v_add_f32_dpp v104, v145, v104 quad_perm:[1,1,1,1] row_mask:0xf bank_mask:0xf
    v_add_f32_dpp v105, v149, v105 quad_perm:[1,1,1,1] row_mask:0xf bank_mask:0xf
    v_add_f32_dpp v106, v153, v106 quad_perm:[1,1,1,1] row_mask:0xf bank_mask:0xf
    v_add_f32_dpp v107, v157, v107 quad_perm:[1,1,1,1] row_mask:0xf bank_mask:0xf
    v_add_f32_dpp v104, v146, v104 quad_perm:[2,2,2,2] row_mask:0xf bank_mask:0xf
    v_add_f32_dpp v105, v150, v105 quad_perm:[2,2,2,2] row_mask:0xf bank_mask:0xf
    v_add_f32_dpp v106, v154, v106 quad_perm:[2,2,2,2] row_mask:0xf bank_mask:0xf
    v_add_f32_dpp v107, v158, v107 quad_perm:[2,2,2,2] row_mask:0xf bank_mask:0xf
    v_add_f32_dpp v104, v147, v104 quad_perm:[3,3,3,3] row_mask:0xf bank_mask:0xf
    v_add_f32_dpp v105, v151, v105 quad_perm:[3,3,3,3] row_mask:0xf bank_mask:0xf
    v_add_f32_dpp v106, v155, v106 quad_perm:[3,3,3,3] row_mask:0xf bank_mask:0xf
    v_add_f32_dpp v107, v159, v107 quad_perm:[3,3,3,3] row_mask:0xf bank_mask:0xf
    v_mfma_f32_16x16x32_bf16 v[144:147], a[32:35], v[20:23], 0
    v_mfma_f32_16x16x32_bf16 v[148:151], a[36:39], v[20:23], 0
    v_mfma_f32_16x16x32_bf16 v[152:155], a[40:43], v[20:23], 0
    v_mfma_f32_16x16x32_bf16 v[156:159], a[44:47], v[20:23], 0
    v_mov_b32_dpp v108, v160 quad_perm:[0,0,0,0] row_mask:0xf bank_mask:0xf
    v_mov_b32_dpp v109, v164 quad_perm:[0,0,0,0] row_mask:0xf bank_mask:0xf
    v_mov_b32_dpp v110, v168 quad_perm:[0,0,0,0] row_mask:0xf bank_mask:0xf
    v_mov_b32_dpp v111, v172 quad_perm:[0,0,0,0] row_mask:0xf bank_mask:0xf
    v_add_f32_dpp v108, v161, v108 quad_perm:[1,1,1,1] row_mask:0xf bank_mask:0xf
    v_add_f32_dpp v109, v165, v109 quad_perm:[1,1,1,1] row_mask:0xf bank_mask:0xf
    v_add_f32_dpp v110, v169, v110 quad_perm:[1,1,1,1] row_mask:0xf bank_mask:0xf
    v_add_f32_dpp v111, v173, v111 quad_perm:[1,1,1,1] row_mask:0xf bank_mask:0xf
    v_add_f32_dpp v108, v162, v108 quad_perm:[2,2,2,2] row_mask:0xf bank_mask:0xf
    v_add_f32_dpp v109, v166, v109 quad_perm:[2,2,2,2] row_mask:0xf bank_mask:0xf
    v_add_f32_dpp v110, v170, v110 quad_perm:[2,2,2,2] row_mask:0xf bank_mask:0xf
    v_add_f32_dpp v111, v174, v111 quad_perm:[2,2,2,2] row_mask:0xf bank_mask:0xf
    v_add_f32_dpp v108, v163, v108 quad_perm:[3,3,3,3] row_mask:0xf bank_mask:0xf
    v_add_f32_dpp v109, v167, v109 quad_perm:[3,3,3,3] row_mask:0xf bank_mask:0xf
    v_add_f32_dpp v110, v171, v110 quad_perm:[3,3,3,3] row_mask:0xf bank_mask:0xf
    v_add_f32_dpp v111, v175, v111 quad_perm:[3,3,3,3] row_mask:0xf bank_mask:0xf
    v_mfma_f32_16x16x32_bf16 v[160:163], a[48:51], v[20:23], 0
    v_mfma_f32_16x16x32_bf16 v[164:167], a[52:55], v[20:23], 0
    v_mfma_f32_16x16x32_bf16 v[168:171], a[56:59], v[20:23], 0
    v_mfma_f32_16x16x32_bf16 v[172:175], a[60:63], v[20:23], 0
    buffer_load_dwordx4 a[176:179], v5, s[48:51], s95 offen sc1 nt
    s_addk_i32 s95, 0x1000
    v_mov_b32_dpp v112, v144 quad_perm:[0,0,0,0] row_mask:0xf bank_mask:0xf
    v_mov_b32_dpp v113, v148 quad_perm:[0,0,0,0] row_mask:0xf bank_mask:0xf
    v_mov_b32_dpp v114, v152 quad_perm:[0,0,0,0] row_mask:0xf bank_mask:0xf
    v_mov_b32_dpp v115, v156 quad_perm:[0,0,0,0] row_mask:0xf bank_mask:0xf
    v_add_f32_dpp v112, v145, v112 quad_perm:[1,1,1,1] row_mask:0xf bank_mask:0xf
    v_add_f32_dpp v113, v149, v113 quad_perm:[1,1,1,1] row_mask:0xf bank_mask:0xf
    v_add_f32_dpp v114, v153, v114 quad_perm:[1,1,1,1] row_mask:0xf bank_mask:0xf
    v_add_f32_dpp v115, v157, v115 quad_perm:[1,1,1,1] row_mask:0xf bank_mask:0xf
    v_add_f32_dpp v112, v146, v112 quad_perm:[2,2,2,2] row_mask:0xf bank_mask:0xf
    v_add_f32_dpp v113, v150, v113 quad_perm:[2,2,2,2] row_mask:0xf bank_mask:0xf
    v_add_f32_dpp v114, v154, v114 quad_perm:[2,2,2,2] row_mask:0xf bank_mask:0xf
    v_add_f32_dpp v115, v158, v115 quad_perm:[2,2,2,2] row_mask:0xf bank_mask:0xf
    v_add_f32_dpp v112, v147, v112 quad_perm:[3,3,3,3] row_mask:0xf bank_mask:0xf
    v_add_f32_dpp v113, v151, v113 quad_perm:[3,3,3,3] row_mask:0xf bank_mask:0xf
    v_add_f32_dpp v114, v155, v114 quad_perm:[3,3,3,3] row_mask:0xf bank_mask:0xf
    v_add_f32_dpp v115, v159, v115 quad_perm:[3,3,3,3] row_mask:0xf bank_mask:0xf
    v_mfma_f32_16x16x32_bf16 v[144:147], a[64:67], v[20:23], 0
    v_mfma_f32_16x16x32_bf16 v[148:151], a[68:71], v[20:23], 0
    v_mfma_f32_16x16x32_bf16 v[152:155], a[72:75], v[20:23], 0
    v_mfma_f32_16x16x32_bf16 v[156:159], a[76:79], v[20:23], 0
    v_mov_b32_dpp v116, v160 quad_perm:[0,0,0,0] row_mask:0xf bank_mask:0xf
    v_mov_b32_dpp v117, v164 quad_perm:[0,0,0,0] row_mask:0xf bank_mask:0xf
    v_mov_b32_dpp v118, v168 quad_perm:[0,0,0,0] row_mask:0xf bank_mask:0xf
    v_mov_b32_dpp v119, v172 quad_perm:[0,0,0,0] row_mask:0xf bank_mask:0xf
    v_add_f32_dpp v116, v161, v116 quad_perm:[1,1,1,1] row_mask:0xf bank_mask:0xf
    v_add_f32_dpp v117, v165, v117 quad_perm:[1,1,1,1] row_mask:0xf bank_mask:0xf
    v_add_f32_dpp v118, v169, v118 quad_perm:[1,1,1,1] row_mask:0xf bank_mask:0xf
    v_add_f32_dpp v119, v173, v119 quad_perm:[1,1,1,1] row_mask:0xf bank_mask:0xf
    v_add_f32_dpp v116, v162, v116 quad_perm:[2,2,2,2] row_mask:0xf bank_mask:0xf
    v_add_f32_dpp v117, v166, v117 quad_perm:[2,2,2,2] row_mask:0xf bank_mask:0xf
    v_add_f32_dpp v118, v170, v118 quad_perm:[2,2,2,2] row_mask:0xf bank_mask:0xf
    v_add_f32_dpp v119, v174, v119 quad_perm:[2,2,2,2] row_mask:0xf bank_mask:0xf
    v_add_f32_dpp v116, v163, v116 quad_perm:[3,3,3,3] row_mask:0xf bank_mask:0xf
    v_add_f32_dpp v117, v167, v117 quad_perm:[3,3,3,3] row_mask:0xf bank_mask:0xf
    v_add_f32_dpp v118, v171, v118 quad_perm:[3,3,3,3] row_mask:0xf bank_mask:0xf
    v_add_f32_dpp v119, v175, v119 quad_perm:[3,3,3,3] row_mask:0xf bank_mask:0xf
    v_mfma_f32_16x16x32_bf16 v[160:163], a[80:83], v[20:23], 0
    v_mfma_f32_16x16x32_bf16 v[164:167], a[84:87], v[20:23], 0
    v_mfma_f32_16x16x32_bf16 v[168:171], a[88:91], v[20:23], 0
    v_mfma_f32_16x16x32_bf16 v[172:175], a[92:95], v[20:23], 0
    buffer_load_dwordx4 a[180:183], v5, s[48:51], s95 offen sc1 nt
    s_addk_i32 s95, 0x1000
    v_mov_b32_dpp v120, v144 quad_perm:[0,0,0,0] row_mask:0xf bank_mask:0xf
    v_mov_b32_dpp v121, v148 quad_perm:[0,0,0,0] row_mask:0xf bank_mask:0xf
    v_mov_b32_dpp v122, v152 quad_perm:[0,0,0,0] row_mask:0xf bank_mask:0xf
    v_mov_b32_dpp v123, v156 quad_perm:[0,0,0,0] row_mask:0xf bank_mask:0xf
    v_add_f32_dpp v120, v145, v120 quad_perm:[1,1,1,1] row_mask:0xf bank_mask:0xf
    v_add_f32_dpp v121, v149, v121 quad_perm:[1,1,1,1] row_mask:0xf bank_mask:0xf
    v_add_f32_dpp v122, v153, v122 quad_perm:[1,1,1,1] row_mask:0xf bank_mask:0xf
    v_add_f32_dpp v123, v157, v123 quad_perm:[1,1,1,1] row_mask:0xf bank_mask:0xf
    v_add_f32_dpp v120, v146, v120 quad_perm:[2,2,2,2] row_mask:0xf bank_mask:0xf
    v_add_f32_dpp v121, v150, v121 quad_perm:[2,2,2,2] row_mask:0xf bank_mask:0xf
    v_add_f32_dpp v122, v154, v122 quad_perm:[2,2,2,2] row_mask:0xf bank_mask:0xf
    v_add_f32_dpp v123, v158, v123 quad_perm:[2,2,2,2] row_mask:0xf bank_mask:0xf
    v_add_f32_dpp v120, v147, v120 quad_perm:[3,3,3,3] row_mask:0xf bank_mask:0xf
    v_add_f32_dpp v121, v151, v121 quad_perm:[3,3,3,3] row_mask:0xf bank_mask:0xf
    v_add_f32_dpp v122, v155, v122 quad_perm:[3,3,3,3] row_mask:0xf bank_mask:0xf
    v_add_f32_dpp v123, v159, v123 quad_perm:[3,3,3,3] row_mask:0xf bank_mask:0xf
    v_mfma_f32_16x16x32_bf16 v[144:147], a[96:99], v[20:23], 0
    v_mfma_f32_16x16x32_bf16 v[148:151], a[100:103], v[20:23], 0
    v_mfma_f32_16x16x32_bf16 v[152:155], a[104:107], v[20:23], 0
    v_mfma_f32_16x16x32_bf16 v[156:159], a[108:111], v[20:23], 0
    v_mov_b32_dpp v124, v160 quad_perm:[0,0,0,0] row_mask:0xf bank_mask:0xf
    v_mov_b32_dpp v125, v164 quad_perm:[0,0,0,0] row_mask:0xf bank_mask:0xf
    v_mov_b32_dpp v126, v168 quad_perm:[0,0,0,0] row_mask:0xf bank_mask:0xf
    v_mov_b32_dpp v127, v172 quad_perm:[0,0,0,0] row_mask:0xf bank_mask:0xf
    v_add_f32_dpp v124, v161, v124 quad_perm:[1,1,1,1] row_mask:0xf bank_mask:0xf
    v_add_f32_dpp v125, v165, v125 quad_perm:[1,1,1,1] row_mask:0xf bank_mask:0xf
    v_add_f32_dpp v126, v169, v126 quad_perm:[1,1,1,1] row_mask:0xf bank_mask:0xf
    v_add_f32_dpp v127, v173, v127 quad_perm:[1,1,1,1] row_mask:0xf bank_mask:0xf
    v_add_f32_dpp v124, v162, v124 quad_perm:[2,2,2,2] row_mask:0xf bank_mask:0xf
    v_add_f32_dpp v125, v166, v125 quad_perm:[2,2,2,2] row_mask:0xf bank_mask:0xf
    v_add_f32_dpp v126, v170, v126 quad_perm:[2,2,2,2] row_mask:0xf bank_mask:0xf
    v_add_f32_dpp v127, v174, v127 quad_perm:[2,2,2,2] row_mask:0xf bank_mask:0xf
    v_add_f32_dpp v124, v163, v124 quad_perm:[3,3,3,3] row_mask:0xf bank_mask:0xf
    v_add_f32_dpp v125, v167, v125 quad_perm:[3,3,3,3] row_mask:0xf bank_mask:0xf
    v_add_f32_dpp v126, v171, v126 quad_perm:[3,3,3,3] row_mask:0xf bank_mask:0xf
    v_add_f32_dpp v127, v175, v127 quad_perm:[3,3,3,3] row_mask:0xf bank_mask:0xf
    v_mfma_f32_16x16x32_bf16 v[160:163], a[112:115], v[20:23], 0
    v_mfma_f32_16x16x32_bf16 v[164:167], a[116:119], v[20:23], 0
    v_mfma_f32_16x16x32_bf16 v[168:171], a[120:123], v[20:23], 0
    v_mfma_f32_16x16x32_bf16 v[172:175], a[124:127], v[20:23], 0
    buffer_load_dwordx4 a[184:187], v5, s[48:51], s95 offen sc1 nt
    s_addk_i32 s95, 0x1000
    v_mov_b32_dpp v128, v144 quad_perm:[0,0,0,0] row_mask:0xf bank_mask:0xf
    v_mov_b32_dpp v129, v148 quad_perm:[0,0,0,0] row_mask:0xf bank_mask:0xf
    v_mov_b32_dpp v130, v152 quad_perm:[0,0,0,0] row_mask:0xf bank_mask:0xf
    v_mov_b32_dpp v131, v156 quad_perm:[0,0,0,0] row_mask:0xf bank_mask:0xf
    v_add_f32_dpp v128, v145, v128 quad_perm:[1,1,1,1] row_mask:0xf bank_mask:0xf
    v_add_f32_dpp v129, v149, v129 quad_perm:[1,1,1,1] row_mask:0xf bank_mask:0xf
    v_add_f32_dpp v130, v153, v130 quad_perm:[1,1,1,1] row_mask:0xf bank_mask:0xf
    v_add_f32_dpp v131, v157, v131 quad_perm:[1,1,1,1] row_mask:0xf bank_mask:0xf
    v_add_f32_dpp v128, v146, v128 quad_perm:[2,2,2,2] row_mask:0xf bank_mask:0xf
    v_add_f32_dpp v129, v150, v129 quad_perm:[2,2,2,2] row_mask:0xf bank_mask:0xf
    v_add_f32_dpp v130, v154, v130 quad_perm:[2,2,2,2] row_mask:0xf bank_mask:0xf
    v_add_f32_dpp v131, v158, v131 quad_perm:[2,2,2,2] row_mask:0xf bank_mask:0xf
    v_add_f32_dpp v128, v147, v128 quad_perm:[3,3,3,3] row_mask:0xf bank_mask:0xf
    v_add_f32_dpp v129, v151, v129 quad_perm:[3,3,3,3] row_mask:0xf bank_mask:0xf
    v_add_f32_dpp v130, v155, v130 quad_perm:[3,3,3,3] row_mask:0xf bank_mask:0xf
    v_add_f32_dpp v131, v159, v131 quad_perm:[3,3,3,3] row_mask:0xf bank_mask:0xf
    v_mfma_f32_16x16x32_bf16 v[144:147], a[128:131], v[20:23], 0
    v_mfma_f32_16x16x32_bf16 v[148:151], a[132:135], v[20:23], 0
    v_mov_b32_dpp v132, v160 quad_perm:[0,0,0,0] row_mask:0xf bank_mask:0xf
    v_mov_b32_dpp v133, v164 quad_perm:[0,0,0,0] row_mask:0xf bank_mask:0xf
    v_mov_b32_dpp v134, v168 quad_perm:[0,0,0,0] row_mask:0xf bank_mask:0xf
    v_mov_b32_dpp v135, v172 quad_perm:[0,0,0,0] row_mask:0xf bank_mask:0xf
    v_add_f32_dpp v132, v161, v132 quad_perm:[1,1,1,1] row_mask:0xf bank_mask:0xf
    v_add_f32_dpp v133, v165, v133 quad_perm:[1,1,1,1] row_mask:0xf bank_mask:0xf
    v_add_f32_dpp v134, v169, v134 quad_perm:[1,1,1,1] row_mask:0xf bank_mask:0xf
    v_add_f32_dpp v135, v173, v135 quad_perm:[1,1,1,1] row_mask:0xf bank_mask:0xf
    v_add_f32_dpp v132, v162, v132 quad_perm:[2,2,2,2] row_mask:0xf bank_mask:0xf
    v_add_f32_dpp v133, v166, v133 quad_perm:[2,2,2,2] row_mask:0xf bank_mask:0xf
    v_add_f32_dpp v134, v170, v134 quad_perm:[2,2,2,2] row_mask:0xf bank_mask:0xf
    v_add_f32_dpp v135, v174, v135 quad_perm:[2,2,2,2] row_mask:0xf bank_mask:0xf
    v_add_f32_dpp v132, v163, v132 quad_perm:[3,3,3,3] row_mask:0xf bank_mask:0xf
    v_add_f32_dpp v133, v167, v133 quad_perm:[3,3,3,3] row_mask:0xf bank_mask:0xf
    v_add_f32_dpp v134, v171, v134 quad_perm:[3,3,3,3] row_mask:0xf bank_mask:0xf
    v_add_f32_dpp v135, v175, v135 quad_perm:[3,3,3,3] row_mask:0xf bank_mask:0xf
    buffer_load_dwordx4 a[188:191], v5, s[48:51], s95 offen sc1 nt
    s_addk_i32 s95, 0x1000
    v_mov_b32_dpp v136, v144 quad_perm:[0,0,0,0] row_mask:0xf bank_mask:0xf
    v_mov_b32_dpp v137, v148 quad_perm:[0,0,0,0] row_mask:0xf bank_mask:0xf
    s_nop 0
    v_add_f32_dpp v136, v145, v136 quad_perm:[1,1,1,1] row_mask:0xf bank_mask:0xf
    v_add_f32_dpp v137, v149, v137 quad_perm:[1,1,1,1] row_mask:0xf bank_mask:0xf
    s_nop 0
    v_add_f32_dpp v136, v146, v136 quad_perm:[2,2,2,2] row_mask:0xf bank_mask:0xf
    v_add_f32_dpp v137, v150, v137 quad_perm:[2,2,2,2] row_mask:0xf bank_mask:0xf
    s_nop 0
    v_add_f32_dpp v136, v147, v136 quad_perm:[3,3,3,3] row_mask:0xf bank_mask:0xf
    v_add_f32_dpp v137, v151, v137 quad_perm:[3,3,3,3] row_mask:0xf bank_mask:0xf
    v_max3_f32 v32, v104, v105, v106
    v_max3_f32 v32, v32, v107, v108
    v_max3_f32 v32, v32, v109, v110
    v_max3_f32 v32, v32, v111, v112
    v_max3_f32 v32, v32, v113, v114
    v_max3_f32 v32, v32, v115, v116
    v_max3_f32 v32, v32, v117, v118
    v_max3_f32 v32, v32, v119, v120
    v_max3_f32 v32, v32, v121, v122
    v_max3_f32 v32, v32, v123, v124
    v_max3_f32 v32, v32, v125, v126
    v_max3_f32 v32, v32, v127, v128
    v_max3_f32 v32, v32, v129, v130
    v_max3_f32 v32, v32, v131, v132
    v_max3_f32 v32, v32, v133, v134
    v_max3_f32 v32, v32, v135, v136
    v_max_f32 v32, v32, v137
    v_mov_b32 v12, v32
    s_nop 1
    v_permlane32_swap_b32 v32, v12
    s_nop 1
    v_max_f32 v32, v32, v12
    v_mov_b32 v12, v32
    s_nop 1
    v_permlane16_swap_b32 v32, v12
    s_nop 1
    v_max_f32 v32, v32, v12
    v_bfe_u32 v13, v1, 3, 1
    v_lshlrev_b32 v13, 4, v13
    s_lshl_b32 s5, s3, 2
    s_add_u32 s5, s5, 19456
    v_add_u32 v14, s5, v13
    v_add_u32 v15, 19456, v13
    s_mov_b64 exec, 0x101
    ds_write_b32 v14, v32
    s_mov_b64 exec, -1
    s_waitcnt lgkmcnt(0)
    s_barrier
    ds_read_b128 v[16:19], v15
    buffer_load_dwordx4 a[192:195], v5, s[48:51], s95 offen sc1 nt
    s_addk_i32 s95, 0x1000
    s_waitcnt lgkmcnt(0)
    v_max3_f32 v32, v16, v17, v18
    v_max_f32 v32, v32, v19
    v_mul_f32 v34, s15, v32
    v_mov_b32 v33, 0
    v_fma_f32 v104, v104, s15, -v34
    v_fma_f32 v105, v105, s15, -v34
    v_fma_f32 v106, v106, s15, -v34
    v_fma_f32 v107, v107, s15, -v34
    v_exp_f32 v104, v104
    v_exp_f32 v105, v105
    v_exp_f32 v106, v106
    v_exp_f32 v107, v107
    v_add_f32 v33, v33, v104
    v_add_f32 v33, v33, v105
    v_add_f32 v33, v33, v106
    v_add_f32 v33, v33, v107
    v_cvt_pk_bf16_f32 v104, v104, v104
    v_cvt_pk_bf16_f32 v105, v105, v105
    v_cvt_pk_bf16_f32 v106, v106, v106
    v_cvt_pk_bf16_f32 v107, v107, v107
    v_fma_f32 v108, v108, s15, -v34
    v_fma_f32 v109, v109, s15, -v34
    v_fma_f32 v110, v110, s15, -v34
    v_fma_f32 v111, v111, s15, -v34
    v_exp_f32 v108, v108
    v_exp_f32 v109, v109
    v_exp_f32 v110, v110
    v_exp_f32 v111, v111
    v_add_f32 v33, v33, v108
    v_add_f32 v33, v33, v109
    v_add_f32 v33, v33, v110
    v_add_f32 v33, v33, v111
    v_cvt_pk_bf16_f32 v108, v108, v108
    v_cvt_pk_bf16_f32 v109, v109, v109
    v_cvt_pk_bf16_f32 v110, v110, v110
    v_cvt_pk_bf16_f32 v111, v111, v111
    buffer_load_dwordx4 a[196:199], v5, s[48:51], s95 offen sc1 nt
    s_addk_i32 s95, 0x1000
    v_fma_f32 v112, v112, s15, -v34
    v_fma_f32 v113, v113, s15, -v34
    v_fma_f32 v114, v114, s15, -v34
    v_fma_f32 v115, v115, s15, -v34
    v_exp_f32 v112, v112
    v_exp_f32 v113, v113
    v_exp_f32 v114, v114
    v_exp_f32 v115, v115
    v_add_f32 v33, v33, v112
    v_add_f32 v33, v33, v113
    v_add_f32 v33, v33, v114
    v_add_f32 v33, v33, v115
    v_cvt_pk_bf16_f32 v112, v112, v112
    v_cvt_pk_bf16_f32 v113, v113, v113
    v_cvt_pk_bf16_f32 v114, v114, v114
    v_cvt_pk_bf16_f32 v115, v115, v115
    v_fma_f32 v116, v116, s15, -v34
    v_fma_f32 v117, v117, s15, -v34
    v_fma_f32 v118, v118, s15, -v34
    v_fma_f32 v119, v119, s15, -v34
    v_exp_f32 v116, v116
    v_exp_f32 v117, v117
    v_exp_f32 v118, v118
    v_exp_f32 v119, v119
    v_add_f32 v33, v33, v116
    v_add_f32 v33, v33, v117
    v_add_f32 v33, v33, v118
    v_add_f32 v33, v33, v119
    v_cvt_pk_bf16_f32 v116, v116, v116
    v_cvt_pk_bf16_f32 v117, v117, v117
    v_cvt_pk_bf16_f32 v118, v118, v118
    v_cvt_pk_bf16_f32 v119, v119, v119
    buffer_load_dwordx4 a[200:203], v5, s[48:51], s95 offen sc1 nt
    s_addk_i32 s95, 0x1000
    v_fma_f32 v120, v120, s15, -v34
    v_fma_f32 v121, v121, s15, -v34
    v_fma_f32 v122, v122, s15, -v34
    v_fma_f32 v123, v123, s15, -v34
    v_exp_f32 v120, v120
    v_exp_f32 v121, v121
    v_exp_f32 v122, v122
    v_exp_f32 v123, v123
    v_add_f32 v33, v33, v120
    v_add_f32 v33, v33, v121
    v_add_f32 v33, v33, v122
    v_add_f32 v33, v33, v123
    v_cvt_pk_bf16_f32 v120, v120, v120
    v_cvt_pk_bf16_f32 v121, v121, v121
    v_cvt_pk_bf16_f32 v122, v122, v122
    v_cvt_pk_bf16_f32 v123, v123, v123
    v_fma_f32 v124, v124, s15, -v34
    v_fma_f32 v125, v125, s15, -v34
    v_fma_f32 v126, v126, s15, -v34
    v_fma_f32 v127, v127, s15, -v34
    v_exp_f32 v124, v124
    v_exp_f32 v125, v125
    v_exp_f32 v126, v126
    v_exp_f32 v127, v127
    v_add_f32 v33, v33, v124
    v_add_f32 v33, v33, v125
    v_add_f32 v33, v33, v126
    v_add_f32 v33, v33, v127
    v_cvt_pk_bf16_f32 v124, v124, v124
    v_cvt_pk_bf16_f32 v125, v125, v125
    v_cvt_pk_bf16_f32 v126, v126, v126
    v_cvt_pk_bf16_f32 v127, v127, v127
    buffer_load_dwordx4 a[204:207], v5, s[48:51], s95 offen sc1 nt
    s_addk_i32 s95, 0x1000
    v_fma_f32 v128, v128, s15, -v34
    v_fma_f32 v129, v129, s15, -v34
    v_fma_f32 v130, v130, s15, -v34
    v_fma_f32 v131, v131, s15, -v34
    v_exp_f32 v128, v128
    v_exp_f32 v129, v129
    v_exp_f32 v130, v130
    v_exp_f32 v131, v131
    v_add_f32 v33, v33, v128
    v_add_f32 v33, v33, v129
    v_add_f32 v33, v33, v130
    v_add_f32 v33, v33, v131
    v_cvt_pk_bf16_f32 v128, v128, v128
    v_cvt_pk_bf16_f32 v129, v129, v129
    v_cvt_pk_bf16_f32 v130, v130, v130
    v_cvt_pk_bf16_f32 v131, v131, v131
    v_fma_f32 v132, v132, s15, -v34
    v_fma_f32 v133, v133, s15, -v34
    v_fma_f32 v134, v134, s15, -v34
    v_fma_f32 v135, v135, s15, -v34
    v_exp_f32 v132, v132
    v_exp_f32 v133, v133
    v_exp_f32 v134, v134
    v_exp_f32 v135, v135
    v_add_f32 v33, v33, v132
    v_add_f32 v33, v33, v133
    v_add_f32 v33, v33, v134
    v_add_f32 v33, v33, v135
    v_cvt_pk_bf16_f32 v132, v132, v132
    v_cvt_pk_bf16_f32 v133, v133, v133
    v_cvt_pk_bf16_f32 v134, v134, v134
    v_cvt_pk_bf16_f32 v135, v135, v135
    buffer_load_dwordx4 a[208:211], v5, s[48:51], s95 offen sc1 nt
    s_addk_i32 s95, 0x1000
    v_fma_f32 v136, v136, s15, -v34
    v_fma_f32 v137, v137, s15, -v34
    v_exp_f32 v136, v136
    v_exp_f32 v137, v137
    s_nop 1
    v_add_f32 v33, v33, v136
    v_add_f32 v33, v33, v137
    v_cvt_pk_bf16_f32 v136, v136, v136
    v_cvt_pk_bf16_f32 v137, v137, v137
    v_mov_b32 v12, v33
    s_nop 1
    v_permlane32_swap_b32 v33, v12
    s_nop 1
    v_add_f32 v33, v33, v12
    v_mov_b32 v12, v33
    s_nop 1
    v_permlane16_swap_b32 v33, v12
    s_nop 1
    v_add_f32 v33, v33, v12
    s_mov_b64 exec, 0x101
    ds_write_b32 v14, v33 offset:32
    s_mov_b64 exec, -1
    v_mov_b32 v28, 0
    v_mov_b32 v29, 0
    v_mov_b32 v30, 0
    v_mov_b32 v31, 0
L_pv_34_0:
    v_and_b32 v168, v104, v40
    v_and_b32 v169, v104, v41
    v_and_b32 v170, v104, v42
    v_and_b32 v171, v104, v43
    buffer_load_dwordx4 a[212:215], v5, s[48:51], s95 offen sc1 nt
    s_addk_i32 s95, 0x1000
    v_and_b32 v172, v105, v40
    v_and_b32 v173, v105, v41
    v_and_b32 v174, v105, v42
    v_and_b32 v175, v105, v43
    s_waitcnt vmcnt(19)
    v_mfma_f32_16x16x32_bf16 v[28:31], a[136:139], v[168:171], v[28:31]
    buffer_load_dwordx4 a[216:219], v5, s[48:51], s95 offen sc1 nt
    s_addk_i32 s95, 0x1000
    v_and_b32 v168, v106, v40
    v_and_b32 v169, v106, v41
    v_and_b32 v170, v106, v42
    v_and_b32 v171, v106, v43
    s_waitcnt vmcnt(19)
    v_mfma_f32_16x16x32_bf16 v[28:31], a[140:143], v[172:175], v[28:31]
    buffer_load_dwordx4 a[220:223], v5, s[48:51], s95 offen sc1 nt
    s_addk_i32 s95, 0x1000
    v_and_b32 v172, v107, v40
    v_and_b32 v173, v107, v41
    v_and_b32 v174, v107, v42
    v_and_b32 v175, v107, v43
    s_waitcnt vmcnt(19)
    v_mfma_f32_16x16x32_bf16 v[28:31], a[144:147], v[168:171], v[28:31]
    buffer_load_dwordx4 a[224:227], v5, s[48:51], s95 offen sc1 nt
    s_addk_i32 s95, 0x1000
    v_and_b32 v168, v108, v40
    v_and_b32 v169, v108, v41
    v_and_b32 v170, v108, v42
    v_and_b32 v171, v108, v43
    s_waitcnt vmcnt(19)
    v_mfma_f32_16x16x32_bf16 v[28:31], a[148:151], v[172:175], v[28:31]
    buffer_load_dwordx4 a[228:231], v5, s[48:51], s95 offen sc1 nt
    s_addk_i32 s95, 0x1000
    v_and_b32 v172, v109, v40
    v_and_b32 v173, v109, v41
    v_and_b32 v174, v109, v42
    v_and_b32 v175, v109, v43
    s_waitcnt vmcnt(19)
    v_mfma_f32_16x16x32_bf16 v[28:31], a[152:155], v[168:171], v[28:31]
    buffer_load_dwordx4 a[232:235], v5, s[48:51], s95 offen sc1 nt
    s_addk_i32 s95, 0x1000
    v_and_b32 v168, v110, v40
    v_and_b32 v169, v110, v41
    v_and_b32 v170, v110, v42
    v_and_b32 v171, v110, v43
    s_waitcnt vmcnt(19)
    v_mfma_f32_16x16x32_bf16 v[28:31], a[156:159], v[172:175], v[28:31]
    buffer_load_dwordx4 a[236:239], v5, s[48:51], s95 offen sc1 nt
    s_addk_i32 s95, 0x1000
    v_and_b32 v172, v111, v40
    v_and_b32 v173, v111, v41
    v_and_b32 v174, v111, v42
    v_and_b32 v175, v111, v43
    s_waitcnt vmcnt(19)
    v_mfma_f32_16x16x32_bf16 v[28:31], a[160:163], v[168:171], v[28:31]
    buffer_load_dwordx4 a[240:243], v5, s[48:51], s95 offen sc1 nt
    s_addk_i32 s95, 0x1000
    v_and_b32 v168, v112, v40
    v_and_b32 v169, v112, v41
    v_and_b32 v170, v112, v42
    v_and_b32 v171, v112, v43
    s_waitcnt vmcnt(19)
    v_mfma_f32_16x16x32_bf16 v[28:31], a[164:167], v[172:175], v[28:31]
    buffer_load_dwordx4 a[244:247], v5, s[48:51], s95 offen sc1 nt
    s_addk_i32 s95, 0x1000
    v_and_b32 v172, v113, v40
    v_and_b32 v173, v113, v41
    v_and_b32 v174, v113, v42
    v_and_b32 v175, v113, v43
    s_waitcnt vmcnt(19)
    v_mfma_f32_16x16x32_bf16 v[28:31], a[168:171], v[168:171], v[28:31]
    s_cmp_eq_u32 s3, 0
    s_cbranch_scc0 L_noclaim14
    s_mov_b64 exec, 1
    buffer_atomic_add v37, off, s[52:55], s42 sc0
    s_mov_b64 exec, -1
L_noclaim14:
    buffer_load_dwordx4 a[248:251], v5, s[48:51], s95 offen sc1 nt
    s_addk_i32 s95, 0x1000
    v_and_b32 v168, v114, v40
    v_and_b32 v169, v114, v41
    v_and_b32 v170, v114, v42
    v_and_b32 v171, v114, v43
    s_waitcnt vmcnt(19)
    v_mfma_f32_16x16x32_bf16 v[28:31], a[172:175], v[172:175], v[28:31]
    buffer_load_dwordx4 a[252:255], v5, s[48:51], s95 offen sc1 nt
    s_addk_i32 s95, 0x1000
    v_and_b32 v172, v115, v40
    v_and_b32 v173, v115, v41
    v_and_b32 v174, v115, v42
    v_and_b32 v175, v115, v43
    s_waitcnt vmcnt(19)
    v_mfma_f32_16x16x32_bf16 v[28:31], a[176:179], v[168:171], v[28:31]
    buffer_load_dwordx4 a[0:3], v5, s[48:51], s95 offen sc1 nt
    s_addk_i32 s95, 0x1000
    v_and_b32 v168, v116, v40
    v_and_b32 v169, v116, v41
    v_and_b32 v170, v116, v42
    v_and_b32 v171, v116, v43
    s_waitcnt vmcnt(19)
    v_mfma_f32_16x16x32_bf16 v[28:31], a[180:183], v[172:175], v[28:31]
    buffer_load_dwordx4 a[4:7], v5, s[48:51], s95 offen sc1 nt
    s_addk_i32 s95, 0x1000
    v_and_b32 v172, v117, v40
    v_and_b32 v173, v117, v41
    v_and_b32 v174, v117, v42
    v_and_b32 v175, v117, v43
    s_waitcnt vmcnt(19)
    v_mfma_f32_16x16x32_bf16 v[28:31], a[184:187], v[168:171], v[28:31]
    buffer_load_dwordx4 a[8:11], v5, s[48:51], s95 offen sc1 nt
    s_addk_i32 s95, 0x1000
    v_and_b32 v168, v118, v40
    v_and_b32 v169, v118, v41
    v_and_b32 v170, v118, v42
    v_and_b32 v171, v118, v43
    s_waitcnt vmcnt(19)
    v_mfma_f32_16x16x32_bf16 v[28:31], a[188:191], v[172:175], v[28:31]
    buffer_load_dwordx4 a[12:15], v5, s[48:51], s95 offen sc1 nt
    s_addk_i32 s95, 0x1000
    v_and_b32 v172, v119, v40
    v_and_b32 v173, v119, v41
    v_and_b32 v174, v119, v42
    v_and_b32 v175, v119, v43
    s_waitcnt vmcnt(19)
    v_mfma_f32_16x16x32_bf16 v[28:31], a[192:195], v[168:171], v[28:31]
    v_and_b32 v168, v120, v40
    v_and_b32 v169, v120, v41
    v_and_b32 v170, v120, v42
    v_and_b32 v171, v120, v43
    s_waitcnt vmcnt(18)
    v_mfma_f32_16x16x32_bf16 v[28:31], a[196:199], v[172:175], v[28:31]
    v_and_b32 v172, v121, v40
    v_and_b32 v173, v121, v41
    v_and_b32 v174, v121, v42
    v_and_b32 v175, v121, v43
    s_waitcnt vmcnt(17)
    v_mfma_f32_16x16x32_bf16 v[28:31], a[200:203], v[168:171], v[28:31]
    v_and_b32 v168, v122, v40
    v_and_b32 v169, v122, v41
    v_and_b32 v170, v122, v42
    v_and_b32 v171, v122, v43
    s_waitcnt vmcnt(16)
    v_mfma_f32_16x16x32_bf16 v[28:31], a[204:207], v[172:175], v[28:31]
    v_and_b32 v172, v123, v40
    v_and_b32 v173, v123, v41
    v_and_b32 v174, v123, v42
    v_and_b32 v175, v123, v43
    s_waitcnt vmcnt(15)
    v_mfma_f32_16x16x32_bf16 v[28:31], a[208:211], v[168:171], v[28:31]
    v_and_b32 v168, v124, v40
    v_and_b32 v169, v124, v41
    v_and_b32 v170, v124, v42
    v_and_b32 v171, v124, v43
    s_waitcnt vmcnt(14)
    v_mfma_f32_16x16x32_bf16 v[28:31], a[212:215], v[172:175], v[28:31]
    v_and_b32 v172, v125, v40
    v_and_b32 v173, v125, v41
    v_and_b32 v174, v125, v42
    v_and_b32 v175, v125, v43
    s_waitcnt vmcnt(13)
    v_mfma_f32_16x16x32_bf16 v[28:31], a[216:219], v[168:171], v[28:31]
    v_and_b32 v168, v126, v40
    v_and_b32 v169, v126, v41
    v_and_b32 v170, v126, v42
    v_and_b32 v171, v126, v43
    s_waitcnt vmcnt(12)
    v_mfma_f32_16x16x32_bf16 v[28:31], a[220:223], v[172:175], v[28:31]
    v_and_b32 v172, v127, v40
    v_and_b32 v173, v127, v41
    v_and_b32 v174, v127, v42
    v_and_b32 v175, v127, v43
    s_waitcnt vmcnt(11)
    v_mfma_f32_16x16x32_bf16 v[28:31], a[224:227], v[168:171], v[28:31]
    v_and_b32 v168, v128, v40
    v_and_b32 v169, v128, v41
    v_and_b32 v170, v128, v42
    v_and_b32 v171, v128, v43
    s_waitcnt vmcnt(10)
    v_mfma_f32_16x16x32_bf16 v[28:31], a[228:231], v[172:175], v[28:31]
    v_and_b32 v172, v129, v40
    v_and_b32 v173, v129, v41
    v_and_b32 v174, v129, v42
    v_and_b32 v175, v129, v43
    s_waitcnt vmcnt(9)
    v_mfma_f32_16x16x32_bf16 v[28:31], a[232:235], v[168:171], v[28:31]
    v_and_b32 v168, v130, v40
    v_and_b32 v169, v130, v41
    v_and_b32 v170, v130, v42
    v_and_b32 v171, v130, v43
    s_waitcnt vmcnt(8)
    v_mfma_f32_16x16x32_bf16 v[28:31], a[236:239], v[172:175], v[28:31]
    v_bfe_u32 v12, v1, 3, 1
    v_mul_u32_u24 v44, 800, v12
    v_mul_u32_u24 v12, 192, v2
    v_add_u32 v44, v44, v12
    v_and_b32 v13, 7, v1
    v_lshl_add_u32 v44, v13, 2, v44
    s_mul_i32 s5, s3, 1600
    s_add_u32 s5, s5, 24576
    v_add_u32 v44, s5, v44
    v_lshrrev_b32 v12, 3, v3
    v_mul_u32_u24 v45, 192, v12
    v_and_b32 v13, 7, v3
    v_lshl_add_u32 v45, v13, 4, v45
    s_lshr_b32 s5, s3, 1
    s_mul_i32 s5, s5, 800
    s_and_b32 s6, s3, 1
    s_mul_i32 s6, s6, 384
    s_add_u32 s5, s5, s6
    s_add_u32 s5, s5, 24576
    v_add_u32 v45, s5, v45
    v_and_b32 v12, 1, v3
    v_lshlrev_b32 v46, 7, v12
    v_lshrrev_b32 v12, 1, v3
    v_lshl_add_u32 v46, v12, 4, v46
    v_and_b32 v12, 7, v1
    v_lshlrev_b32 v12, 4, v12
    v_add_u32 v12, 256, v12
    v_cmp_lt_u32 vcc, 15, v1
    s_lshr_b32 s5, s3, 1
    s_lshl_b32 s5, s5, 3
    v_cndmask_b32 v46, v46, v12, vcc
    v_readlane_b32 s6, v32, s5
    s_nop 1
    v_mov_b32 v34, s6
    v_mul_f32 v34, s15, v34
    v_and_b32 v172, v131, v40
    v_and_b32 v173, v131, v41
    v_and_b32 v174, v131, v42
    v_and_b32 v175, v131, v43
    s_waitcnt vmcnt(7)
    v_mfma_f32_16x16x32_bf16 v[28:31], a[240:243], v[168:171], v[28:31]
    v_and_b32 v168, v132, v40
    v_and_b32 v169, v132, v41
    v_and_b32 v170, v132, v42
    v_and_b32 v171, v132, v43
    s_waitcnt vmcnt(6)
    v_mfma_f32_16x16x32_bf16 v[28:31], a[244:247], v[172:175], v[28:31]
    v_and_b32 v172, v133, v40
    v_and_b32 v173, v133, v41
    v_and_b32 v174, v133, v42
    v_and_b32 v175, v133, v43
    s_waitcnt vmcnt(5)
    v_mfma_f32_16x16x32_bf16 v[28:31], a[248:251], v[168:171], v[28:31]
    v_and_b32 v168, v134, v40
    v_and_b32 v169, v134, v41
    v_and_b32 v170, v134, v42
    v_and_b32 v171, v134, v43
    s_waitcnt vmcnt(4)
    v_mfma_f32_16x16x32_bf16 v[28:31], a[252:255], v[172:175], v[28:31]
    v_and_b32 v172, v135, v40
    v_and_b32 v173, v135, v41
    v_and_b32 v174, v135, v42
    v_and_b32 v175, v135, v43
    s_waitcnt vmcnt(3)
    v_mfma_f32_16x16x32_bf16 v[28:31], a[0:3], v[168:171], v[28:31]
    v_and_b32 v168, v136, v40
    v_and_b32 v169, v136, v41
    v_and_b32 v170, v136, v42
    v_and_b32 v171, v136, v43
    s_waitcnt vmcnt(2)
    v_mfma_f32_16x16x32_bf16 v[28:31], a[4:7], v[172:175], v[28:31]
    v_and_b32 v172, v137, v40
    v_and_b32 v173, v137, v41
    v_and_b32 v174, v137, v42
    v_and_b32 v175, v137, v43
    s_waitcnt vmcnt(1)
    v_mfma_f32_16x16x32_bf16 v[28:31], a[8:11], v[168:171], v[28:31]
    s_nop 1
    s_waitcnt vmcnt(0)
    v_mfma_f32_16x16x32_bf16 v[28:31], a[12:15], v[172:175], v[28:31]
    v_mov_b32 v13, 19584
    s_cmp_eq_u32 s3, 0
    s_cbranch_scc0 L_norank15
    s_waitcnt vmcnt(0)
    s_mov_b64 exec, 1
    ds_write_b32 v13, v37
    s_mov_b64 exec, -1
L_norank15:
    s_lshr_b32 s5, s3, 1
    s_lshl_b32 s5, s5, 4
    s_add_u32 s6, s5, 19456
    v_mov_b32 v15, s6
    v_mov_b32 v17, v7
    v_mov_b32 v19, v7
    s_nop 2
    ds_write_b32 v44, v28
    ds_write_b32 v44, v29 offset:32
    ds_write_b32 v44, v30 offset:64
    ds_write_b32 v44, v31 offset:96
    s_waitcnt lgkmcnt(0)
    s_barrier
    ds_read_b32 v37, v13
    ds_read_b128 v[88:91], v15 offset:32
    ds_read_b128 v[72:75], v45
    ds_read_b128 v[76:79], v45 offset:1600
    ds_read_b128 v[80:83], v45 offset:3200
    ds_read_b128 v[84:87], v45 offset:4800
    s_waitcnt lgkmcnt(4)
    v_add_f32 v88, v88, v89
    v_add_f32 v90, v90, v91
    s_waitcnt lgkmcnt(2)
    v_add_f32 v72, v72, v76
    v_add_f32 v73, v73, v77
    v_add_f32 v74, v74, v78
    v_add_f32 v75, v75, v79
    v_add_f32 v94, v88, v90
    s_waitcnt lgkmcnt(0)
    v_add_f32 v80, v80, v84
    v_add_f32 v81, v81, v85
    v_add_f32 v82, v82, v86
    v_add_f32 v83, v83, v87
    v_add_f32 v72, v72, v80
    v_add_f32 v73, v73, v81
    v_add_f32 v74, v74, v82
    v_add_f32 v75, v75, v83
    v_cvt_pk_bf16_f32 v16, v72, v73
    v_cvt_pk_bf16_f32 v18, v74, v75
    s_mov_b64 exec, 0xff0000
    v_mov_b32 v16, v34
    v_mov_b32 v18, v94
    s_mov_b64 exec, 0xffffff
    buffer_store_dwordx4 v[16:19], v46, s[52:55], s101 offen sc1
    s_mov_b64 exec, -1
    s_branch L_tail_0
L_tail_0:
    v_readfirstlane_b32 s43, v37
    s_and_b32 s87, s4, 15
    s_cmp_lt_u32 s87, 8
    s_cselect_b32 s5, 3, 1
    s_cmp_eq_u32 s87, 0
    s_cselect_b32 s5, 4, s5
    s_cmp_lt_u32 s43, s5
    s_cbranch_scc1 L_tail_2
    s_sub_u32 s6, s43, s5
    s_cmp_lt_u32 s6, 9
    s_cbranch_scc1 L_tail_wo
    s_cmp_eq_u32 s87, 0
    s_cselect_b32 s7, 10, 11
    s_cmp_ge_u32 s6, s7
    s_cbranch_scc1 L_fin
    s_lshl_b32 s7, s87, 1
    s_add_u32 s7, s7, s6
    s_sub_u32 s7, s7, 10
    s_cmp_eq_u32 s87, 0
    s_cselect_b32 s87, 0, s7
    s_branch L_reducer
L_tail_2:
    s_mul_i32 s7, s87, 3
    s_add_u32 s7, s7, 1
    s_add_u32 s6, s87, 17
    s_cmp_lt_u32 s87, 8
    s_cselect_b32 s7, s7, s6
    s_cmp_eq_u32 s87, 0
    s_cselect_b32 s7, 0, s7
    s_add_u32 s8, s7, s43
    s_add_u32 s100, s8, 145
    s_mul_i32 s5, s8, 57
    s_lshr_b32 s87, s5, 9
    s_mov_b32 s14, 2
    s_lshl_b32 s5, s87, 3
    s_add_u32 s5, s5, s3
    s_add_u32 s5, s5, 65
    s_lshl_b32 s5, s5, 13
    s_add_u32 s93, s5, 2048
    s_add_u32 s5, s93, 0
    buffer_load_dwordx4 v[176:179], v9, s[52:55], s5 offen sc1
    buffer_load_dwordx4 v[180:183], v9, s[52:55], s5 offen offset:1024 sc1
    s_add_u32 s5, s93, 589824
    buffer_load_dwordx4 v[184:187], v9, s[52:55], s5 offen sc1
    buffer_load_dwordx4 v[188:191], v9, s[52:55], s5 offen offset:1024 sc1
    s_add_u32 s5, s93, 32768
    buffer_load_dwordx4 v[56:59], v9, s[52:55], s5 offen sc1
    buffer_load_dwordx4 v[60:63], v9, s[52:55], s5 offen offset:1024 sc1
    s_add_u32 s5, s93, 622592
    buffer_load_dwordx4 v[64:67], v9, s[52:55], s5 offen sc1
    buffer_load_dwordx4 v[68:71], v9, s[52:55], s5 offen offset:1024 sc1
    s_mul_i32 s6, s87, 9
    s_sub_u32 s6, s8, s6
    s_mul_i32 s7, s87, 589824
    s_lshl_b32 s8, s6, 7
    s_add_u32 s7, s7, s8
    s_add_u32 s88, s88, s7
    s_mov_b32 s60, s32
    s_and_b32 s61, s33, 0xffff
    s_mov_b32 s62, 5308416
    s_lshl_b32 s100, s100, 13
    s_add_u32 s100, s100, 4096
    v_lshrrev_b32 v12, 3, v1
    s_lshl_b32 s5, s3, 3
    v_add_u32 v12, s5, v12
    v_mul_u32_u24 v36, 1152, v12
    v_and_b32 v13, 7, v1
    v_lshl_add_u32 v36, v13, 4, v36
    v_lshlrev_b32 v47, 9, v13
    v_lshl_add_u32 v47, v12, 4, v47
    s_waitcnt vmcnt(0)
    s_add_u32 s13, s88, 0
    buffer_load_dwordx4 v[192:195], v11, s[60:63], s13 offen offset:0 sc1 nt
    buffer_load_dwordx4 v[196:199], v11, s[60:63], s13 offen offset:1152 sc1 nt
    buffer_load_dwordx4 v[200:203], v11, s[60:63], s13 offen offset:2304 sc1 nt
    buffer_load_dwordx4 v[204:207], v11, s[60:63], s13 offen offset:3456 sc1 nt
    s_add_u32 s13, s88, 4608
    buffer_load_dwordx4 v[208:211], v11, s[60:63], s13 offen offset:0 sc1 nt
    buffer_load_dwordx4 v[212:215], v11, s[60:63], s13 offen offset:1152 sc1 nt
    buffer_load_dwordx4 v[216:219], v11, s[60:63], s13 offen offset:2304 sc1 nt
    buffer_load_dwordx4 v[220:223], v11, s[60:63], s13 offen offset:3456 sc1 nt
    s_add_u32 s13, s88, 294912
    buffer_load_dwordx4 v[224:227], v11, s[60:63], s13 offen offset:0 sc1 nt
    buffer_load_dwordx4 v[228:231], v11, s[60:63], s13 offen offset:1152 sc1 nt
    buffer_load_dwordx4 v[232:235], v11, s[60:63], s13 offen offset:2304 sc1 nt
    buffer_load_dwordx4 v[236:239], v11, s[60:63], s13 offen offset:3456 sc1 nt
    s_add_u32 s13, s88, 299520
    buffer_load_dwordx4 v[240:243], v11, s[60:63], s13 offen offset:0 sc1 nt
    buffer_load_dwordx4 v[244:247], v11, s[60:63], s13 offen offset:1152 sc1 nt
    buffer_load_dwordx4 v[248:251], v11, s[60:63], s13 offen offset:2304 sc1 nt
    buffer_load_dwordx4 v[252:255], v11, s[60:63], s13 offen offset:3456 sc1 nt
    s_mov_b32 s85, 0
L_guchk16:
    v_xor_b32 v12, s84, v177
    v_bitop3_b32 v12, v179, s84, v12 bitop3:0xbe
    v_bitop3_b32 v12, v181, s84, v12 bitop3:0xbe
    v_bitop3_b32 v12, v183, s84, v12 bitop3:0xbe
    v_bitop3_b32 v12, v185, s84, v12 bitop3:0xbe
    v_bitop3_b32 v12, v187, s84, v12 bitop3:0xbe
    v_bitop3_b32 v12, v189, s84, v12 bitop3:0xbe
    v_bitop3_b32 v12, v191, s84, v12 bitop3:0xbe
    v_bitop3_b32 v12, v57, s84, v12 bitop3:0xbe
    v_bitop3_b32 v12, v59, s84, v12 bitop3:0xbe
    v_bitop3_b32 v12, v61, s84, v12 bitop3:0xbe
    v_bitop3_b32 v12, v63, s84, v12 bitop3:0xbe
    v_bitop3_b32 v12, v65, s84, v12 bitop3:0xbe
    v_bitop3_b32 v12, v67, s84, v12 bitop3:0xbe
    v_bitop3_b32 v12, v69, s84, v12 bitop3:0xbe
    v_bitop3_b32 v12, v71, s84, v12 bitop3:0xbe
    v_cmp_ne_u32 vcc, 0, v12
    s_cbranch_vccz L_guok17
    s_add_u32 s85, s85, 1
    s_cmp_gt_u32 s85, 4096
    s_cbranch_scc1 L_guok17
    s_sleep 2
    s_add_u32 s5, s93, 0
    buffer_load_dwordx4 v[176:179], v9, s[52:55], s5 offen sc1
    buffer_load_dwordx4 v[180:183], v9, s[52:55], s5 offen offset:1024 sc1
    s_add_u32 s5, s93, 589824
    buffer_load_dwordx4 v[184:187], v9, s[52:55], s5 offen sc1
    buffer_load_dwordx4 v[188:191], v9, s[52:55], s5 offen offset:1024 sc1
    s_add_u32 s5, s93, 32768
    buffer_load_dwordx4 v[56:59], v9, s[52:55], s5 offen sc1
    buffer_load_dwordx4 v[60:63], v9, s[52:55], s5 offen offset:1024 sc1
    s_add_u32 s5, s93, 622592
    buffer_load_dwordx4 v[64:67], v9, s[52:55], s5 offen sc1
    buffer_load_dwordx4 v[68:71], v9, s[52:55], s5 offen offset:1024 sc1
    s_waitcnt vmcnt(0)
    s_branch L_guchk16
L_guok17:
    v_lshlrev_b32 v72, 16, v176
    v_and_b32 v73, 0xffff0000, v176
    v_lshlrev_b32 v74, 16, v184
    v_and_b32 v75, 0xffff0000, v184
    v_lshlrev_b32 v76, 16, v178
    v_and_b32 v77, 0xffff0000, v178
    v_lshlrev_b32 v78, 16, v186
    v_and_b32 v79, 0xffff0000, v186
    v_lshlrev_b32 v80, 16, v180
    v_and_b32 v81, 0xffff0000, v180
    v_lshlrev_b32 v82, 16, v188
    v_and_b32 v83, 0xffff0000, v188
    v_lshlrev_b32 v84, 16, v182
    v_and_b32 v85, 0xffff0000, v182
    v_lshlrev_b32 v86, 16, v190
    v_and_b32 v87, 0xffff0000, v190
    v_mul_f32 v74, v74, v72
    v_mul_f32 v75, v75, v73
    v_mul_f32 v72, 0xbfb8aa3b, v72
    v_mul_f32 v73, 0xbfb8aa3b, v73
    v_mul_f32 v78, v78, v76
    v_mul_f32 v79, v79, v77
    v_mul_f32 v76, 0xbfb8aa3b, v76
    v_mul_f32 v77, 0xbfb8aa3b, v77
    v_mul_f32 v82, v82, v80
    v_mul_f32 v83, v83, v81
    v_mul_f32 v80, 0xbfb8aa3b, v80
    v_mul_f32 v81, 0xbfb8aa3b, v81
    v_mul_f32 v86, v86, v84
    v_mul_f32 v87, v87, v85
    v_mul_f32 v84, 0xbfb8aa3b, v84
    v_mul_f32 v85, 0xbfb8aa3b, v85
    v_exp_f32 v72, v72
    v_exp_f32 v73, v73
    v_exp_f32 v76, v76
    v_exp_f32 v77, v77
    v_exp_f32 v80, v80
    v_exp_f32 v81, v81
    v_exp_f32 v84, v84
    v_exp_f32 v85, v85
    v_add_f32 v72, 1.0, v72
    v_add_f32 v73, 1.0, v73
    v_add_f32 v76, 1.0, v76
    v_add_f32 v77, 1.0, v77
    v_add_f32 v80, 1.0, v80
    v_add_f32 v81, 1.0, v81
    v_add_f32 v84, 1.0, v84
    v_add_f32 v85, 1.0, v85
    v_rcp_f32 v72, v72
    v_rcp_f32 v73, v73
    v_rcp_f32 v76, v76
    v_rcp_f32 v77, v77
    v_rcp_f32 v80, v80
    v_rcp_f32 v81, v81
    v_rcp_f32 v84, v84
    v_rcp_f32 v85, v85
    v_mul_f32 v74, v74, v72
    v_mul_f32 v75, v75, v73
    v_mul_f32 v78, v78, v76
    v_mul_f32 v79, v79, v77
    v_mul_f32 v82, v82, v80
    v_mul_f32 v83, v83, v81
    v_mul_f32 v86, v86, v84
    v_mul_f32 v87, v87, v85
    v_cvt_pk_bf16_f32 v48, v74, v75
    v_cvt_pk_bf16_f32 v49, v78, v79
    v_cvt_pk_bf16_f32 v50, v82, v83
    v_cvt_pk_bf16_f32 v51, v86, v87
    v_lshlrev_b32 v88, 16, v56
    v_and_b32 v89, 0xffff0000, v56
    v_lshlrev_b32 v90, 16, v64
    v_and_b32 v91, 0xffff0000, v64
    v_lshlrev_b32 v92, 16, v58
    v_and_b32 v93, 0xffff0000, v58
    v_lshlrev_b32 v94, 16, v66
    v_and_b32 v95, 0xffff0000, v66
    v_lshlrev_b32 v96, 16, v60
    v_and_b32 v97, 0xffff0000, v60
    v_lshlrev_b32 v98, 16, v68
    v_and_b32 v99, 0xffff0000, v68
    v_lshlrev_b32 v100, 16, v62
    v_and_b32 v101, 0xffff0000, v62
    v_lshlrev_b32 v102, 16, v70
    v_and_b32 v103, 0xffff0000, v70
    v_mul_f32 v90, v90, v88
    v_mul_f32 v91, v91, v89
    v_mul_f32 v88, 0xbfb8aa3b, v88
    v_mul_f32 v89, 0xbfb8aa3b, v89
    v_mul_f32 v94, v94, v92
    v_mul_f32 v95, v95, v93
    v_mul_f32 v92, 0xbfb8aa3b, v92
    v_mul_f32 v93, 0xbfb8aa3b, v93
    v_mul_f32 v98, v98, v96
    v_mul_f32 v99, v99, v97
    v_mul_f32 v96, 0xbfb8aa3b, v96
    v_mul_f32 v97, 0xbfb8aa3b, v97
    v_mul_f32 v102, v102, v100
    v_mul_f32 v103, v103, v101
    v_mul_f32 v100, 0xbfb8aa3b, v100
    v_mul_f32 v101, 0xbfb8aa3b, v101
    v_exp_f32 v88, v88
    v_exp_f32 v89, v89
    v_exp_f32 v92, v92
    v_exp_f32 v93, v93
    v_exp_f32 v96, v96
    v_exp_f32 v97, v97
    v_exp_f32 v100, v100
    v_exp_f32 v101, v101
    v_add_f32 v88, 1.0, v88
    v_add_f32 v89, 1.0, v89
    v_add_f32 v92, 1.0, v92
    v_add_f32 v93, 1.0, v93
    v_add_f32 v96, 1.0, v96
    v_add_f32 v97, 1.0, v97
    v_add_f32 v100, 1.0, v100
    v_add_f32 v101, 1.0, v101
    v_rcp_f32 v88, v88
    v_rcp_f32 v89, v89
    v_rcp_f32 v92, v92
    v_rcp_f32 v93, v93
    v_rcp_f32 v96, v96
    v_rcp_f32 v97, v97
    v_rcp_f32 v100, v100
    v_rcp_f32 v101, v101
    v_mul_f32 v90, v90, v88
    v_mul_f32 v91, v91, v89
    v_mul_f32 v94, v94, v92
    v_mul_f32 v95, v95, v93
    v_mul_f32 v98, v98, v96
    v_mul_f32 v99, v99, v97
    v_mul_f32 v102, v102, v100
    v_mul_f32 v103, v103, v101
    v_cvt_pk_bf16_f32 v52, v90, v91
    v_cvt_pk_bf16_f32 v53, v94, v95
    v_cvt_pk_bf16_f32 v54, v98, v99
    v_cvt_pk_bf16_f32 v55, v102, v103
    s_waitcnt vmcnt(8)
    v_perm_b32 v144, v196, v192, s9
    v_perm_b32 v145, v204, v200, s9
    v_perm_b32 v146, v212, v208, s9
    v_perm_b32 v147, v220, v216, s9
    v_perm_b32 v148, v196, v192, s10
    v_perm_b32 v149, v204, v200, s10
    v_perm_b32 v150, v212, v208, s10
    v_perm_b32 v151, v220, v216, s10
    v_perm_b32 v152, v197, v193, s9
    v_perm_b32 v153, v205, v201, s9
    v_perm_b32 v154, v213, v209, s9
    v_perm_b32 v155, v221, v217, s9
    v_perm_b32 v156, v197, v193, s10
    v_perm_b32 v157, v205, v201, s10
    v_perm_b32 v158, v213, v209, s10
    v_perm_b32 v159, v221, v217, s10
    v_perm_b32 v160, v198, v194, s9
    v_perm_b32 v161, v206, v202, s9
    v_perm_b32 v162, v214, v210, s9
    v_perm_b32 v163, v222, v218, s9
    v_perm_b32 v164, v198, v194, s10
    v_perm_b32 v165, v206, v202, s10
    v_perm_b32 v166, v214, v210, s10
    v_perm_b32 v167, v222, v218, s10
    v_perm_b32 v168, v199, v195, s9
    v_perm_b32 v169, v207, v203, s9
    v_perm_b32 v170, v215, v211, s9
    v_perm_b32 v171, v223, v219, s9
    v_perm_b32 v172, v199, v195, s10
    v_perm_b32 v173, v207, v203, s10
    v_perm_b32 v174, v215, v211, s10
    v_perm_b32 v175, v223, v219, s10
    s_waitcnt vmcnt(0)
    v_perm_b32 v104, v228, v224, s9
    v_perm_b32 v105, v236, v232, s9
    v_perm_b32 v106, v244, v240, s9
    v_perm_b32 v107, v252, v248, s9
    v_perm_b32 v108, v228, v224, s10
    v_perm_b32 v109, v236, v232, s10
    v_perm_b32 v110, v244, v240, s10
    v_perm_b32 v111, v252, v248, s10
    v_perm_b32 v112, v229, v225, s9
    v_perm_b32 v113, v237, v233, s9
    v_perm_b32 v114, v245, v241, s9
    v_perm_b32 v115, v253, v249, s9
    v_perm_b32 v116, v229, v225, s10
    v_perm_b32 v117, v237, v233, s10
    v_perm_b32 v118, v245, v241, s10
    v_perm_b32 v119, v253, v249, s10
    v_perm_b32 v120, v230, v226, s9
    v_perm_b32 v121, v238, v234, s9
    v_perm_b32 v122, v246, v242, s9
    v_perm_b32 v123, v254, v250, s9
    v_perm_b32 v124, v230, v226, s10
    v_perm_b32 v125, v238, v234, s10
    v_perm_b32 v126, v246, v242, s10
    v_perm_b32 v127, v254, v250, s10
    v_perm_b32 v128, v231, v227, s9
    v_perm_b32 v129, v239, v235, s9
    v_perm_b32 v130, v247, v243, s9
    v_perm_b32 v131, v255, v251, s9
    v_perm_b32 v132, v231, v227, s10
    v_perm_b32 v133, v239, v235, s10
    v_perm_b32 v134, v247, v243, s10
    v_perm_b32 v135, v255, v251, s10
L_big_mfma:
    s_nop 1
    v_mfma_f32_16x16x32_bf16 v[72:75], v[144:147], v[48:51], 0
    v_mfma_f32_16x16x32_bf16 v[76:79], v[148:151], v[48:51], 0
    v_mfma_f32_16x16x32_bf16 v[80:83], v[152:155], v[48:51], 0
    v_mfma_f32_16x16x32_bf16 v[84:87], v[156:159], v[48:51], 0
    v_mfma_f32_16x16x32_bf16 v[88:91], v[160:163], v[48:51], 0
    v_mfma_f32_16x16x32_bf16 v[92:95], v[164:167], v[48:51], 0
    v_mfma_f32_16x16x32_bf16 v[96:99], v[168:171], v[48:51], 0
    v_mfma_f32_16x16x32_bf16 v[100:103], v[172:175], v[48:51], 0
    v_mfma_f32_16x16x32_bf16 v[72:75], v[104:107], v[52:55], v[72:75]
    v_mfma_f32_16x16x32_bf16 v[76:79], v[108:111], v[52:55], v[76:79]
    v_mfma_f32_16x16x32_bf16 v[80:83], v[112:115], v[52:55], v[80:83]
    v_mfma_f32_16x16x32_bf16 v[84:87], v[116:119], v[52:55], v[84:87]
    v_mfma_f32_16x16x32_bf16 v[88:91], v[120:123], v[52:55], v[88:91]
    v_mfma_f32_16x16x32_bf16 v[92:95], v[124:127], v[52:55], v[92:95]
    v_mfma_f32_16x16x32_bf16 v[96:99], v[128:131], v[52:55], v[96:99]
    v_mfma_f32_16x16x32_bf16 v[100:103], v[132:135], v[52:55], v[100:103]
    s_nop 7
    s_nop 0
    s_mov_b32 exec_lo, 0x00FF00FF
    s_mov_b32 exec_hi, 0xFF00FF00
    ds_write_b128 v35, v[72:75] offset:0
    ds_write_b128 v35, v[76:79] offset:2304
    ds_write_b128 v35, v[80:83] offset:4608
    ds_write_b128 v35, v[84:87] offset:6912
    ds_write_b128 v35, v[88:91] offset:9216
    ds_write_b128 v35, v[92:95] offset:11520
    ds_write_b128 v35, v[96:99] offset:13824
    ds_write_b128 v35, v[100:103] offset:16128
    s_mov_b64 exec, -1
    s_waitcnt lgkmcnt(0)
    s_barrier
    s_cmp_ge_u32 s3, 2
    s_cbranch_scc1 L_w2pub18
    v_mov_b32 v137, v7
    v_mov_b32 v139, v7
    v_mov_b32 v141, v7
    v_mov_b32 v143, v7
    ds_read_b128 v[104:107], v36 offset:0
    ds_read_b128 v[108:111], v36 offset:128
    ds_read_b128 v[112:115], v36 offset:256
    ds_read_b128 v[116:119], v36 offset:384
    ds_read_b128 v[120:123], v36 offset:512
    ds_read_b128 v[124:127], v36 offset:640
    ds_read_b128 v[128:131], v36 offset:768
    ds_read_b128 v[132:135], v36 offset:896
    s_waitcnt lgkmcnt(6)
    v_add_f32 v104, v104, v108
    v_add_f32 v105, v105, v109
    v_add_f32 v106, v106, v110
    v_add_f32 v107, v107, v111
    s_waitcnt lgkmcnt(5)
    v_add_f32 v104, v104, v112
    v_add_f32 v105, v105, v113
    v_add_f32 v106, v106, v114
    v_add_f32 v107, v107, v115
    s_waitcnt lgkmcnt(4)
    v_add_f32 v104, v104, v116
    v_add_f32 v105, v105, v117
    v_add_f32 v106, v106, v118
    v_add_f32 v107, v107, v119
    s_waitcnt lgkmcnt(3)
    v_add_f32 v104, v104, v120
    v_add_f32 v105, v105, v121
    v_add_f32 v106, v106, v122
    v_add_f32 v107, v107, v123
    s_waitcnt lgkmcnt(2)
    v_add_f32 v104, v104, v124
    v_add_f32 v105, v105, v125
    v_add_f32 v106, v106, v126
    v_add_f32 v107, v107, v127
    s_waitcnt lgkmcnt(1)
    v_add_f32 v104, v104, v128
    v_add_f32 v105, v105, v129
    v_add_f32 v106, v106, v130
    v_add_f32 v107, v107, v131
    s_waitcnt lgkmcnt(0)
    v_add_f32 v136, v104, v132
    v_add_f32 v138, v105, v133
    v_add_f32 v140, v106, v134
    v_add_f32 v142, v107, v135
    buffer_store_dwordx4 v[136:139], v47, s[52:55], s100 offen offset:0 sc1
    buffer_store_dwordx4 v[140:143], v47, s[52:55], s100 offen offset:256 sc1
L_w2pub18:
    s_cmp_eq_u32 s14, 2
    s_cbranch_scc1 L_fin
    s_cmp_ge_u32 s2, 249
    s_cbranch_scc1 L_fin
    s_sub_u32 s87, s2, 177
    s_branch L_reducer
L_tail_3:
    s_mov_b32 s43, 99
    s_waitcnt vmcnt(1)
    s_mov_b32 s85, 0
L_guchk19:
    v_xor_b32 v12, s84, v177
    v_bitop3_b32 v12, v179, s84, v12 bitop3:0xbe
    v_bitop3_b32 v12, v181, s84, v12 bitop3:0xbe
    v_bitop3_b32 v12, v183, s84, v12 bitop3:0xbe
    v_bitop3_b32 v12, v185, s84, v12 bitop3:0xbe
    v_bitop3_b32 v12, v187, s84, v12 bitop3:0xbe
    v_bitop3_b32 v12, v189, s84, v12 bitop3:0xbe
    v_bitop3_b32 v12, v191, s84, v12 bitop3:0xbe
    v_bitop3_b32 v12, v57, s84, v12 bitop3:0xbe
    v_bitop3_b32 v12, v59, s84, v12 bitop3:0xbe
    v_bitop3_b32 v12, v61, s84, v12 bitop3:0xbe
    v_bitop3_b32 v12, v63, s84, v12 bitop3:0xbe
    v_bitop3_b32 v12, v65, s84, v12 bitop3:0xbe
    v_bitop3_b32 v12, v67, s84, v12 bitop3:0xbe
    v_bitop3_b32 v12, v69, s84, v12 bitop3:0xbe
    v_bitop3_b32 v12, v71, s84, v12 bitop3:0xbe
    v_cmp_ne_u32 vcc, 0, v12
    s_cbranch_vccz L_guok20
    s_add_u32 s85, s85, 1
    s_cmp_gt_u32 s85, 4096
    s_cbranch_scc1 L_guok20
    s_sleep 2
    s_add_u32 s5, s93, 0
    buffer_load_dwordx4 v[176:179], v9, s[52:55], s5 offen sc1
    buffer_load_dwordx4 v[180:183], v9, s[52:55], s5 offen offset:1024 sc1
    s_add_u32 s5, s93, 589824
    buffer_load_dwordx4 v[184:187], v9, s[52:55], s5 offen sc1
    buffer_load_dwordx4 v[188:191], v9, s[52:55], s5 offen offset:1024 sc1
    s_add_u32 s5, s93, 32768
    buffer_load_dwordx4 v[56:59], v9, s[52:55], s5 offen sc1
    buffer_load_dwordx4 v[60:63], v9, s[52:55], s5 offen offset:1024 sc1
    s_add_u32 s5, s93, 622592
    buffer_load_dwordx4 v[64:67], v9, s[52:55], s5 offen sc1
    buffer_load_dwordx4 v[68:71], v9, s[52:55], s5 offen offset:1024 sc1
    s_waitcnt vmcnt(0)
    s_branch L_guchk19
L_guok20:
    v_lshlrev_b32 v72, 16, v176
    v_and_b32 v73, 0xffff0000, v176
    v_lshlrev_b32 v74, 16, v184
    v_and_b32 v75, 0xffff0000, v184
    v_lshlrev_b32 v76, 16, v178
    v_and_b32 v77, 0xffff0000, v178
    v_lshlrev_b32 v78, 16, v186
    v_and_b32 v79, 0xffff0000, v186
    v_lshlrev_b32 v80, 16, v180
    v_and_b32 v81, 0xffff0000, v180
    v_lshlrev_b32 v82, 16, v188
    v_and_b32 v83, 0xffff0000, v188
    v_lshlrev_b32 v84, 16, v182
    v_and_b32 v85, 0xffff0000, v182
    v_lshlrev_b32 v86, 16, v190
    v_and_b32 v87, 0xffff0000, v190
    v_mul_f32 v74, v74, v72
    v_mul_f32 v75, v75, v73
    v_mul_f32 v72, 0xbfb8aa3b, v72
    v_mul_f32 v73, 0xbfb8aa3b, v73
    v_mul_f32 v78, v78, v76
    v_mul_f32 v79, v79, v77
    v_mul_f32 v76, 0xbfb8aa3b, v76
    v_mul_f32 v77, 0xbfb8aa3b, v77
    v_mul_f32 v82, v82, v80
    v_mul_f32 v83, v83, v81
    v_mul_f32 v80, 0xbfb8aa3b, v80
    v_mul_f32 v81, 0xbfb8aa3b, v81
    v_mul_f32 v86, v86, v84
    v_mul_f32 v87, v87, v85
    v_mul_f32 v84, 0xbfb8aa3b, v84
    v_mul_f32 v85, 0xbfb8aa3b, v85
    v_exp_f32 v72, v72
    v_exp_f32 v73, v73
    v_exp_f32 v76, v76
    v_exp_f32 v77, v77
    v_exp_f32 v80, v80
    v_exp_f32 v81, v81
    v_exp_f32 v84, v84
    v_exp_f32 v85, v85
    v_add_f32 v72, 1.0, v72
    v_add_f32 v73, 1.0, v73
    v_add_f32 v76, 1.0, v76
    v_add_f32 v77, 1.0, v77
    v_add_f32 v80, 1.0, v80
    v_add_f32 v81, 1.0, v81
    v_add_f32 v84, 1.0, v84
    v_add_f32 v85, 1.0, v85
    v_rcp_f32 v72, v72
    v_rcp_f32 v73, v73
    v_rcp_f32 v76, v76
    v_rcp_f32 v77, v77
    v_rcp_f32 v80, v80
    v_rcp_f32 v81, v81
    v_rcp_f32 v84, v84
    v_rcp_f32 v85, v85
    v_mul_f32 v74, v74, v72
    v_mul_f32 v75, v75, v73
    v_mul_f32 v78, v78, v76
    v_mul_f32 v79, v79, v77
    v_mul_f32 v82, v82, v80
    v_mul_f32 v83, v83, v81
    v_mul_f32 v86, v86, v84
    v_mul_f32 v87, v87, v85
    v_cvt_pk_bf16_f32 v48, v74, v75
    v_cvt_pk_bf16_f32 v49, v78, v79
    v_cvt_pk_bf16_f32 v50, v82, v83
    v_cvt_pk_bf16_f32 v51, v86, v87
    v_lshlrev_b32 v88, 16, v56
    v_and_b32 v89, 0xffff0000, v56
    v_lshlrev_b32 v90, 16, v64
    v_and_b32 v91, 0xffff0000, v64
    v_lshlrev_b32 v92, 16, v58
    v_and_b32 v93, 0xffff0000, v58
    v_lshlrev_b32 v94, 16, v66
    v_and_b32 v95, 0xffff0000, v66
    v_lshlrev_b32 v96, 16, v60
    v_and_b32 v97, 0xffff0000, v60
    v_lshlrev_b32 v98, 16, v68
    v_and_b32 v99, 0xffff0000, v68
    v_lshlrev_b32 v100, 16, v62
    v_and_b32 v101, 0xffff0000, v62
    v_lshlrev_b32 v102, 16, v70
    v_and_b32 v103, 0xffff0000, v70
    v_mul_f32 v90, v90, v88
    v_mul_f32 v91, v91, v89
    v_mul_f32 v88, 0xbfb8aa3b, v88
    v_mul_f32 v89, 0xbfb8aa3b, v89
    v_mul_f32 v94, v94, v92
    v_mul_f32 v95, v95, v93
    v_mul_f32 v92, 0xbfb8aa3b, v92
    v_mul_f32 v93, 0xbfb8aa3b, v93
    v_mul_f32 v98, v98, v96
    v_mul_f32 v99, v99, v97
    v_mul_f32 v96, 0xbfb8aa3b, v96
    v_mul_f32 v97, 0xbfb8aa3b, v97
    v_mul_f32 v102, v102, v100
    v_mul_f32 v103, v103, v101
    v_mul_f32 v100, 0xbfb8aa3b, v100
    v_mul_f32 v101, 0xbfb8aa3b, v101
    v_exp_f32 v88, v88
    v_exp_f32 v89, v89
    v_exp_f32 v92, v92
    v_exp_f32 v93, v93
    v_exp_f32 v96, v96
    v_exp_f32 v97, v97
    v_exp_f32 v100, v100
    v_exp_f32 v101, v101
    v_add_f32 v88, 1.0, v88
    v_add_f32 v89, 1.0, v89
    v_add_f32 v92, 1.0, v92
    v_add_f32 v93, 1.0, v93
    v_add_f32 v96, 1.0, v96
    v_add_f32 v97, 1.0, v97
    v_add_f32 v100, 1.0, v100
    v_add_f32 v101, 1.0, v101
    v_rcp_f32 v88, v88
    v_rcp_f32 v89, v89
    v_rcp_f32 v92, v92
    v_rcp_f32 v93, v93
    v_rcp_f32 v96, v96
    v_rcp_f32 v97, v97
    v_rcp_f32 v100, v100
    v_rcp_f32 v101, v101
    v_mul_f32 v90, v90, v88
    v_mul_f32 v91, v91, v89
    v_mul_f32 v94, v94, v92
    v_mul_f32 v95, v95, v93
    v_mul_f32 v98, v98, v96
    v_mul_f32 v99, v99, v97
    v_mul_f32 v102, v102, v100
    v_mul_f32 v103, v103, v101
    v_cvt_pk_bf16_f32 v52, v90, v91
    v_cvt_pk_bf16_f32 v53, v94, v95
    v_cvt_pk_bf16_f32 v54, v98, v99
    v_cvt_pk_bf16_f32 v55, v102, v103
    v_lshrrev_b32 v12, 3, v1
    s_lshl_b32 s5, s3, 3
    v_add_u32 v12, s5, v12
    v_mul_u32_u24 v36, 1152, v12
    v_and_b32 v13, 7, v1
    v_lshl_add_u32 v36, v13, 4, v36
    v_lshlrev_b32 v47, 9, v13
    v_lshl_add_u32 v47, v12, 4, v47
    v_perm_b32 v144, v196, v192, s9
    v_perm_b32 v145, v204, v200, s9
    v_perm_b32 v146, v212, v208, s9
    v_perm_b32 v147, v220, v216, s9
    v_perm_b32 v148, v196, v192, s10
    v_perm_b32 v149, v204, v200, s10
    v_perm_b32 v150, v212, v208, s10
    v_perm_b32 v151, v220, v216, s10
    v_perm_b32 v152, v197, v193, s9
    v_perm_b32 v153, v205, v201, s9
    v_perm_b32 v154, v213, v209, s9
    v_perm_b32 v155, v221, v217, s9
    v_perm_b32 v156, v197, v193, s10
    v_perm_b32 v157, v205, v201, s10
    v_perm_b32 v158, v213, v209, s10
    v_perm_b32 v159, v221, v217, s10
    v_perm_b32 v160, v198, v194, s9
    v_perm_b32 v161, v206, v202, s9
    v_perm_b32 v162, v214, v210, s9
    v_perm_b32 v163, v222, v218, s9
    v_perm_b32 v164, v198, v194, s10
    v_perm_b32 v165, v206, v202, s10
    v_perm_b32 v166, v214, v210, s10
    v_perm_b32 v167, v222, v218, s10
    v_perm_b32 v168, v199, v195, s9
    v_perm_b32 v169, v207, v203, s9
    v_perm_b32 v170, v215, v211, s9
    v_perm_b32 v171, v223, v219, s9
    v_perm_b32 v172, v199, v195, s10
    v_perm_b32 v173, v207, v203, s10
    v_perm_b32 v174, v215, v211, s10
    v_perm_b32 v175, v223, v219, s10
    v_perm_b32 v104, v228, v224, s9
    v_perm_b32 v105, v236, v232, s9
    v_perm_b32 v106, v244, v240, s9
    v_perm_b32 v107, v252, v248, s9
    v_perm_b32 v108, v228, v224, s10
    v_perm_b32 v109, v236, v232, s10
    v_perm_b32 v110, v244, v240, s10
    v_perm_b32 v111, v252, v248, s10
    v_perm_b32 v112, v229, v225, s9
    v_perm_b32 v113, v237, v233, s9
    v_perm_b32 v114, v245, v241, s9
    v_perm_b32 v115, v253, v249, s9
    v_perm_b32 v116, v229, v225, s10
    v_perm_b32 v117, v237, v233, s10
    v_perm_b32 v118, v245, v241, s10
    v_perm_b32 v119, v253, v249, s10
    v_perm_b32 v120, v230, v226, s9
    v_perm_b32 v121, v238, v234, s9
    v_perm_b32 v122, v246, v242, s9
    v_perm_b32 v123, v254, v250, s9
    v_perm_b32 v124, v230, v226, s10
    v_perm_b32 v125, v238, v234, s10
    v_perm_b32 v126, v246, v242, s10
    v_perm_b32 v127, v254, v250, s10
    v_perm_b32 v128, v231, v227, s9
    v_perm_b32 v129, v239, v235, s9
    v_perm_b32 v130, v247, v243, s9
    v_perm_b32 v131, v255, v251, s9
    v_perm_b32 v132, v231, v227, s10
    v_perm_b32 v133, v239, v235, s10
    v_perm_b32 v134, v247, v243, s10
    v_perm_b32 v135, v255, v251, s10
    s_branch L_big_mfma
L_tail_wo:
    v_and_b32 v12, 7, v1
    v_mul_u32_u24 v38, 3072, v12
    v_add_u32 v16, 256, v38
    v_bfe_u32 v12, v1, 3, 1
    v_lshl_add_u32 v38, v12, 6, v38
    v_lshl_add_u32 v38, v2, 4, v38
    s_mul_i32 s5, s87, 24576
    s_add_u32 s5, s5, 2228224
    s_mul_i32 s8, s3, 384
    s_add_u32 s89, s5, s8
    s_mul_i32 s7, s87, 294912
    s_lshl_b32 s8, s6, 7
    s_add_u32 s7, s7, s8
    s_add_u32 s88, s88, s7
    s_mov_b32 s60, s24
    s_and_b32 s61, s25, 0xffff
    s_mov_b32 s62, 4718592
    s_mul_i32 s5, s87, 9
    s_add_u32 s100, s5, s6
    s_add_u32 s100, s100, 1
    s_lshl_b32 s100, s100, 13
    s_add_u32 s100, s100, 4096
    s_mov_b32 s85, 0
    s_cmp_ge_u32 s6, 0
    s_cbranch_scc0 L_wo_early
    s_add_u32 s13, s88, 0
    buffer_load_dwordx4 v[192:195], v11, s[60:63], s13 offen offset:0 sc1 nt
    buffer_load_dwordx4 v[196:199], v11, s[60:63], s13 offen offset:1152 sc1 nt
    buffer_load_dwordx4 v[200:203], v11, s[60:63], s13 offen offset:2304 sc1 nt
    buffer_load_dwordx4 v[204:207], v11, s[60:63], s13 offen offset:3456 sc1 nt
    s_add_u32 s13, s88, 4608
    buffer_load_dwordx4 v[208:211], v11, s[60:63], s13 offen offset:0 sc1 nt
    buffer_load_dwordx4 v[212:215], v11, s[60:63], s13 offen offset:1152 sc1 nt
    buffer_load_dwordx4 v[216:219], v11, s[60:63], s13 offen offset:2304 sc1 nt
    buffer_load_dwordx4 v[220:223], v11, s[60:63], s13 offen offset:3456 sc1 nt
    v_lshrrev_b32 v12, 3, v1
    s_lshl_b32 s5, s3, 3
    v_add_u32 v12, s5, v12
    v_mul_u32_u24 v36, 1152, v12
    v_and_b32 v13, 7, v1
    v_lshl_add_u32 v36, v13, 4, v36
    v_lshlrev_b32 v47, 9, v13
    v_lshl_add_u32 v47, v12, 4, v47
    s_waitcnt vmcnt(0)
    buffer_load_dwordx4 v[176:179], v38, s[52:55], s89 offen sc1
    buffer_load_dwordx4 v[180:183], v38, s[52:55], s89 offen offset:128 sc1
    buffer_load_dwordx4 v[184:187], v38, s[52:55], s89 offen offset:1536 sc1
    buffer_load_dwordx4 v[188:191], v38, s[52:55], s89 offen offset:1664 sc1
    buffer_load_dwordx4 v[56:59], v16, s[52:55], s89 offen sc1
    buffer_load_dwordx4 v[60:63], v16, s[52:55], s89 offen offset:1536 sc1
    v_perm_b32 v144, v196, v192, s9
    v_perm_b32 v145, v204, v200, s9
    v_perm_b32 v146, v212, v208, s9
    v_perm_b32 v147, v220, v216, s9
    v_perm_b32 v148, v196, v192, s10
    v_perm_b32 v149, v204, v200, s10
    v_perm_b32 v150, v212, v208, s10
    v_perm_b32 v151, v220, v216, s10
    v_perm_b32 v152, v197, v193, s9
    v_perm_b32 v153, v205, v201, s9
    v_perm_b32 v154, v213, v209, s9
    v_perm_b32 v155, v221, v217, s9
    v_perm_b32 v156, v197, v193, s10
    v_perm_b32 v157, v205, v201, s10
    v_perm_b32 v158, v213, v209, s10
    v_perm_b32 v159, v221, v217, s10
    v_perm_b32 v160, v198, v194, s9
    v_perm_b32 v161, v206, v202, s9
    v_perm_b32 v162, v214, v210, s9
    v_perm_b32 v163, v222, v218, s9
    v_perm_b32 v164, v198, v194, s10
    v_perm_b32 v165, v206, v202, s10
    v_perm_b32 v166, v214, v210, s10
    v_perm_b32 v167, v222, v218, s10
    v_perm_b32 v168, v199, v195, s9
    v_perm_b32 v169, v207, v203, s9
    v_perm_b32 v170, v215, v211, s9
    v_perm_b32 v171, v223, v219, s9
    v_perm_b32 v172, v199, v195, s10
    v_perm_b32 v173, v207, v203, s10
    v_perm_b32 v174, v215, v211, s10
    v_perm_b32 v175, v223, v219, s10
    s_branch L_o_chk0
    s_add_u32 s13, s88, 0
    buffer_load_dwordx4 v[192:195], v11, s[60:63], s13 offen offset:0 sc1 nt
    buffer_load_dwordx4 v[196:199], v11, s[60:63], s13 offen offset:1152 sc1 nt
    buffer_load_dwordx4 v[200:203], v11, s[60:63], s13 offen offset:2304 sc1 nt
    buffer_load_dwordx4 v[204:207], v11, s[60:63], s13 offen offset:3456 sc1 nt
    s_add_u32 s13, s88, 4608
    buffer_load_dwordx4 v[208:211], v11, s[60:63], s13 offen offset:0 sc1 nt
    buffer_load_dwordx4 v[212:215], v11, s[60:63], s13 offen offset:1152 sc1 nt
    buffer_load_dwordx4 v[216:219], v11, s[60:63], s13 offen offset:2304 sc1 nt
    buffer_load_dwordx4 v[220:223], v11, s[60:63], s13 offen offset:3456 sc1 nt
    v_lshrrev_b32 v12, 3, v1
    s_lshl_b32 s5, s3, 3
    v_add_u32 v12, s5, v12
    v_mul_u32_u24 v36, 1152, v12
    v_and_b32 v13, 7, v1
    v_lshl_add_u32 v36, v13, 4, v36
    v_lshlrev_b32 v47, 9, v13
    v_lshl_add_u32 v47, v12, 4, v47
    s_waitcnt vmcnt(8)
    v_xor_b32 v12, s84, v177
    v_bitop3_b32 v12, v179, s84, v12 bitop3:0xbe
    v_bitop3_b32 v12, v181, s84, v12 bitop3:0xbe
    v_bitop3_b32 v12, v183, s84, v12 bitop3:0xbe
    v_bitop3_b32 v12, v185, s84, v12 bitop3:0xbe
    v_bitop3_b32 v12, v187, s84, v12 bitop3:0xbe
    v_bitop3_b32 v12, v189, s84, v12 bitop3:0xbe
    v_bitop3_b32 v12, v191, s84, v12 bitop3:0xbe
    v_bitop3_b32 v12, v57, s84, v12 bitop3:0xbe
    v_bitop3_b32 v12, v59, s84, v12 bitop3:0xbe
    v_bitop3_b32 v12, v61, s84, v12 bitop3:0xbe
    v_bitop3_b32 v12, v63, s84, v12 bitop3:0xbe
    v_cmp_ne_u32 vcc, 0, v12
    s_branch L_wo_common
L_wo_early:
    v_lshrrev_b32 v12, 3, v1
    s_lshl_b32 s5, s3, 3
    v_add_u32 v12, s5, v12
    v_mul_u32_u24 v36, 1152, v12
    v_and_b32 v13, 7, v1
    v_lshl_add_u32 v36, v13, 4, v36
    v_lshlrev_b32 v47, 9, v13
    v_lshl_add_u32 v47, v12, 4, v47
L_wo_epoll:
    s_waitcnt vmcnt(0)
    v_xor_b32 v12, s84, v177
    v_bitop3_b32 v12, v179, s84, v12 bitop3:0xbe
    v_bitop3_b32 v12, v181, s84, v12 bitop3:0xbe
    v_bitop3_b32 v12, v183, s84, v12 bitop3:0xbe
    v_bitop3_b32 v12, v185, s84, v12 bitop3:0xbe
    v_bitop3_b32 v12, v187, s84, v12 bitop3:0xbe
    v_bitop3_b32 v12, v189, s84, v12 bitop3:0xbe
    v_bitop3_b32 v12, v191, s84, v12 bitop3:0xbe
    v_bitop3_b32 v12, v57, s84, v12 bitop3:0xbe
    v_bitop3_b32 v12, v59, s84, v12 bitop3:0xbe
    v_bitop3_b32 v12, v61, s84, v12 bitop3:0xbe
    v_bitop3_b32 v12, v63, s84, v12 bitop3:0xbe
    v_cmp_ne_u32 vcc, 0, v12
    s_add_u32 s13, s88, 0
    buffer_load_dwordx4 v[192:195], v11, s[60:63], s13 offen offset:0 sc1 nt
    buffer_load_dwordx4 v[196:199], v11, s[60:63], s13 offen offset:1152 sc1 nt
    buffer_load_dwordx4 v[200:203], v11, s[60:63], s13 offen offset:2304 sc1 nt
    buffer_load_dwordx4 v[204:207], v11, s[60:63], s13 offen offset:3456 sc1 nt
    s_add_u32 s13, s88, 4608
    buffer_load_dwordx4 v[208:211], v11, s[60:63], s13 offen offset:0 sc1 nt
    buffer_load_dwordx4 v[212:215], v11, s[60:63], s13 offen offset:1152 sc1 nt
    buffer_load_dwordx4 v[216:219], v11, s[60:63], s13 offen offset:2304 sc1 nt
    buffer_load_dwordx4 v[220:223], v11, s[60:63], s13 offen offset:3456 sc1 nt
L_wo_common:
    s_cbranch_vccnz L_o_first_fail
    s_waitcnt vmcnt(0)
    v_perm_b32 v144, v196, v192, s9
    v_perm_b32 v145, v204, v200, s9
    v_perm_b32 v146, v212, v208, s9
    v_perm_b32 v147, v220, v216, s9
    v_perm_b32 v148, v196, v192, s10
    v_perm_b32 v149, v204, v200, s10
    v_perm_b32 v150, v212, v208, s10
    v_perm_b32 v151, v220, v216, s10
    v_perm_b32 v152, v197, v193, s9
    v_perm_b32 v153, v205, v201, s9
    v_perm_b32 v154, v213, v209, s9
    v_perm_b32 v155, v221, v217, s9
    v_perm_b32 v156, v197, v193, s10
    v_perm_b32 v157, v205, v201, s10
    v_perm_b32 v158, v213, v209, s10
    v_perm_b32 v159, v221, v217, s10
    v_perm_b32 v160, v198, v194, s9
    v_perm_b32 v161, v206, v202, s9
    v_perm_b32 v162, v214, v210, s9
    v_perm_b32 v163, v222, v218, s9
    v_perm_b32 v164, v198, v194, s10
    v_perm_b32 v165, v206, v202, s10
    v_perm_b32 v166, v214, v210, s10
    v_perm_b32 v167, v222, v218, s10
    v_perm_b32 v168, v199, v195, s9
    v_perm_b32 v169, v207, v203, s9
    v_perm_b32 v170, v215, v211, s9
    v_perm_b32 v171, v223, v219, s9
    v_perm_b32 v172, v199, v195, s10
    v_perm_b32 v173, v207, v203, s10
    v_perm_b32 v174, v215, v211, s10
    v_perm_b32 v175, v223, v219, s10
    s_branch L_o_ok0
L_o_first_fail:
    s_mov_b64 exec, vcc
    buffer_load_dwordx4 v[176:179], v38, s[52:55], s89 offen sc1
    buffer_load_dwordx4 v[180:183], v38, s[52:55], s89 offen offset:128 sc1
    buffer_load_dwordx4 v[184:187], v38, s[52:55], s89 offen offset:1536 sc1
    buffer_load_dwordx4 v[188:191], v38, s[52:55], s89 offen offset:1664 sc1
    buffer_load_dwordx4 v[56:59], v16, s[52:55], s89 offen sc1
    buffer_load_dwordx4 v[60:63], v16, s[52:55], s89 offen offset:1536 sc1
    s_mov_b64 exec, -1
    s_waitcnt vmcnt(6)
    v_perm_b32 v144, v196, v192, s9
    v_perm_b32 v145, v204, v200, s9
    v_perm_b32 v146, v212, v208, s9
    v_perm_b32 v147, v220, v216, s9
    v_perm_b32 v148, v196, v192, s10
    v_perm_b32 v149, v204, v200, s10
    v_perm_b32 v150, v212, v208, s10
    v_perm_b32 v151, v220, v216, s10
    v_perm_b32 v152, v197, v193, s9
    v_perm_b32 v153, v205, v201, s9
    v_perm_b32 v154, v213, v209, s9
    v_perm_b32 v155, v221, v217, s9
    v_perm_b32 v156, v197, v193, s10
    v_perm_b32 v157, v205, v201, s10
    v_perm_b32 v158, v213, v209, s10
    v_perm_b32 v159, v221, v217, s10
    v_perm_b32 v160, v198, v194, s9
    v_perm_b32 v161, v206, v202, s9
    v_perm_b32 v162, v214, v210, s9
    v_perm_b32 v163, v222, v218, s9
    v_perm_b32 v164, v198, v194, s10
    v_perm_b32 v165, v206, v202, s10
    v_perm_b32 v166, v214, v210, s10
    v_perm_b32 v167, v222, v218, s10
    v_perm_b32 v168, v199, v195, s9
    v_perm_b32 v169, v207, v203, s9
    v_perm_b32 v170, v215, v211, s9
    v_perm_b32 v171, v223, v219, s9
    v_perm_b32 v172, v199, v195, s10
    v_perm_b32 v173, v207, v203, s10
    v_perm_b32 v174, v215, v211, s10
    v_perm_b32 v175, v223, v219, s10
L_o_chk0:
L_o_chk:
    s_waitcnt vmcnt(0)
    v_xor_b32 v12, s84, v177
    v_bitop3_b32 v12, v179, s84, v12 bitop3:0xbe
    v_bitop3_b32 v12, v181, s84, v12 bitop3:0xbe
    v_bitop3_b32 v12, v183, s84, v12 bitop3:0xbe
    v_bitop3_b32 v12, v185, s84, v12 bitop3:0xbe
    v_bitop3_b32 v12, v187, s84, v12 bitop3:0xbe
    v_bitop3_b32 v12, v189, s84, v12 bitop3:0xbe
    v_bitop3_b32 v12, v191, s84, v12 bitop3:0xbe
    v_bitop3_b32 v12, v57, s84, v12 bitop3:0xbe
    v_bitop3_b32 v12, v59, s84, v12 bitop3:0xbe
    v_bitop3_b32 v12, v61, s84, v12 bitop3:0xbe
    v_bitop3_b32 v12, v63, s84, v12 bitop3:0xbe
    v_cmp_ne_u32 vcc, 0, v12
    s_cbranch_vccz L_o_ok0
    s_mov_b64 exec, vcc
    s_sleep 2
    buffer_load_dwordx4 v[176:179], v38, s[52:55], s89 offen sc1
    buffer_load_dwordx4 v[180:183], v38, s[52:55], s89 offen offset:128 sc1
    buffer_load_dwordx4 v[184:187], v38, s[52:55], s89 offen offset:1536 sc1
    buffer_load_dwordx4 v[188:191], v38, s[52:55], s89 offen offset:1664 sc1
    buffer_load_dwordx4 v[56:59], v16, s[52:55], s89 offen sc1
    buffer_load_dwordx4 v[60:63], v16, s[52:55], s89 offen offset:1536 sc1
    s_mov_b64 exec, -1
    s_add_u32 s85, s85, 1
    s_cmp_gt_u32 s85, 4096
    s_cbranch_scc0 L_o_chk
L_o_ok0:
    v_max_f32 v12, v56, v60
    v_sub_f32 v13, v56, v12
    v_sub_f32 v14, v60, v12
    v_exp_f32 v13, v13
    v_exp_f32 v14, v14
    v_lshlrev_b32 v104, 16, v176
    v_and_b32 v105, 0xffff0000, v176
    v_lshlrev_b32 v106, 16, v184
    v_and_b32 v107, 0xffff0000, v184
    v_mul_f32 v15, v13, v58
    v_fmac_f32 v15, v14, v62
    v_lshlrev_b32 v108, 16, v178
    v_and_b32 v109, 0xffff0000, v178
    v_lshlrev_b32 v110, 16, v186
    v_and_b32 v111, 0xffff0000, v186
    v_rcp_f32 v15, v15
    v_lshlrev_b32 v112, 16, v180
    v_and_b32 v113, 0xffff0000, v180
    v_lshlrev_b32 v114, 16, v188
    v_and_b32 v115, 0xffff0000, v188
    v_lshlrev_b32 v116, 16, v182
    v_and_b32 v117, 0xffff0000, v182
    v_lshlrev_b32 v118, 16, v190
    v_and_b32 v119, 0xffff0000, v190
    v_mul_f32 v13, v13, v15
    v_mul_f32 v14, v14, v15
    s_nop 0
    v_mul_f32 v104, v104, v13
    v_mul_f32 v105, v105, v13
    v_mul_f32 v108, v108, v13
    v_mul_f32 v109, v109, v13
    v_mul_f32 v112, v112, v13
    v_mul_f32 v113, v113, v13
    v_mul_f32 v116, v116, v13
    v_mul_f32 v117, v117, v13
    v_fmac_f32 v104, v106, v14
    v_fmac_f32 v105, v107, v14
    v_fmac_f32 v108, v110, v14
    v_fmac_f32 v109, v111, v14
    v_fmac_f32 v112, v114, v14
    v_fmac_f32 v113, v115, v14
    v_fmac_f32 v116, v118, v14
    v_fmac_f32 v117, v119, v14
    v_cvt_pk_bf16_f32 v48, v104, v105
    v_cvt_pk_bf16_f32 v49, v108, v109
    v_cvt_pk_bf16_f32 v50, v112, v113
    v_cvt_pk_bf16_f32 v51, v116, v117
L_o_mfma:
    s_nop 1
    v_mfma_f32_16x16x32_bf16 v[72:75], v[144:147], v[48:51], 0
    v_mfma_f32_16x16x32_bf16 v[76:79], v[148:151], v[48:51], 0
    v_mfma_f32_16x16x32_bf16 v[80:83], v[152:155], v[48:51], 0
    v_mfma_f32_16x16x32_bf16 v[84:87], v[156:159], v[48:51], 0
    v_mfma_f32_16x16x32_bf16 v[88:91], v[160:163], v[48:51], 0
    v_mfma_f32_16x16x32_bf16 v[92:95], v[164:167], v[48:51], 0
    v_mfma_f32_16x16x32_bf16 v[96:99], v[168:171], v[48:51], 0
    v_mfma_f32_16x16x32_bf16 v[100:103], v[172:175], v[48:51], 0
    s_nop 7
    s_nop 0
    s_mov_b32 exec_lo, 0x00FF00FF
    s_mov_b32 exec_hi, 0xFF00FF00
    ds_write_b128 v35, v[72:75] offset:0
    ds_write_b128 v35, v[76:79] offset:2304
    ds_write_b128 v35, v[80:83] offset:4608
    ds_write_b128 v35, v[84:87] offset:6912
    ds_write_b128 v35, v[88:91] offset:9216
    ds_write_b128 v35, v[92:95] offset:11520
    ds_write_b128 v35, v[96:99] offset:13824
    ds_write_b128 v35, v[100:103] offset:16128
    s_mov_b64 exec, -1
    s_waitcnt lgkmcnt(0)
    s_barrier
    s_cmp_ge_u32 s3, 2
    s_cbranch_scc1 L_w2pub21
    v_mov_b32 v137, v7
    v_mov_b32 v139, v7
    v_mov_b32 v141, v7
    v_mov_b32 v143, v7
    ds_read_b128 v[104:107], v36 offset:0
    ds_read_b128 v[108:111], v36 offset:128
    ds_read_b128 v[112:115], v36 offset:256
    ds_read_b128 v[116:119], v36 offset:384
    ds_read_b128 v[120:123], v36 offset:512
    ds_read_b128 v[124:127], v36 offset:640
    ds_read_b128 v[128:131], v36 offset:768
    ds_read_b128 v[132:135], v36 offset:896
    s_waitcnt lgkmcnt(6)
    v_add_f32 v104, v104, v108
    v_add_f32 v105, v105, v109
    v_add_f32 v106, v106, v110
    v_add_f32 v107, v107, v111
    s_waitcnt lgkmcnt(5)
    v_add_f32 v104, v104, v112
    v_add_f32 v105, v105, v113
    v_add_f32 v106, v106, v114
    v_add_f32 v107, v107, v115
    s_waitcnt lgkmcnt(4)
    v_add_f32 v104, v104, v116
    v_add_f32 v105, v105, v117
    v_add_f32 v106, v106, v118
    v_add_f32 v107, v107, v119
    s_waitcnt lgkmcnt(3)
    v_add_f32 v104, v104, v120
    v_add_f32 v105, v105, v121
    v_add_f32 v106, v106, v122
    v_add_f32 v107, v107, v123
    s_waitcnt lgkmcnt(2)
    v_add_f32 v104, v104, v124
    v_add_f32 v105, v105, v125
    v_add_f32 v106, v106, v126
    v_add_f32 v107, v107, v127
    s_waitcnt lgkmcnt(1)
    v_add_f32 v104, v104, v128
    v_add_f32 v105, v105, v129
    v_add_f32 v106, v106, v130
    v_add_f32 v107, v107, v131
    s_waitcnt lgkmcnt(0)
    v_add_f32 v136, v104, v132
    v_add_f32 v138, v105, v133
    v_add_f32 v140, v106, v134
    v_add_f32 v142, v107, v135
    buffer_store_dwordx4 v[136:139], v47, s[52:55], s100 offen offset:0 sc1
    buffer_store_dwordx4 v[140:143], v47, s[52:55], s100 offen offset:256 sc1
L_w2pub21:
    s_branch L_fin
L_reducer:
    s_mov_b32 s14, s87
    s_and_b32 s88, s87, 7
    s_lshr_b32 s87, s87, 3
    s_mov_b32 s60, s34
    s_and_b32 s61, s35, 0xffff
    s_mov_b32 s62, 1152
    s_mov_b32 s56, s16
    s_and_b32 s57, s17, 0xffff
    v_lshlrev_b32 v12, 4, v1
    s_mul_i32 s6, s88, 1152
    s_add_u32 s7, s6, 1024
    s_movk_i32 s8, 1024
    buffer_load_dwordx4 v[104:107], v12, s[56:59], s6 offen
    buffer_load_dwordx4 v[108:111], v12, s[60:63], 0 offen
    v_mov_b32 v112, 0
    v_mov_b32 v113, 0
    v_mov_b32 v114, 0
    v_mov_b32 v115, 0
    v_mov_b32 v116, 0
    v_mov_b32 v117, 0
    v_mov_b32 v118, 0
    v_mov_b32 v119, 0
    s_mov_b64 exec, 0xff
    buffer_load_dwordx4 v[112:115], v12, s[56:59], s7 offen
    buffer_load_dwordx4 v[116:119], v12, s[60:63], s8 offen
    s_mov_b64 exec, -1
    v_mov_b32 v14, 0
    v_lshrrev_b32 v16, 3, v1
    v_mul_u32_u24 v38, 73728, v16
    v_and_b32 v17, 7, v1
    v_lshl_add_u32 v38, v17, 4, v38
    v_lshlrev_b32 v44, 4, v17
    s_add_u32 s5, s87, 1
    s_lshl_b32 s5, s5, 13
    s_lshl_b32 s6, s88, 9
    s_add_u32 s89, s5, s6
    s_lshl_b32 s6, s3, 7
    s_add_u32 s89, s89, s6
    s_add_u32 s89, s89, 4096
    s_add_u32 s90, s89, 589824
    s_add_u32 s91, s89, 1179648
    s_add_u32 s86, s89, 1769472
    v_and_b32 v45, 1, v1
    v_lshlrev_b32 v45, 6, v45
    v_bfe_u32 v16, v1, 1, 2
    v_lshl_add_u32 v45, v16, 1, v45
    s_lshr_b32 s5, s3, 1
    s_lshl_b32 s5, s5, 5
    s_and_b32 s6, s3, 1
    s_lshl_b32 s6, s6, 3
    s_add_u32 s5, s5, s6
    s_mul_i32 s6, s88, 1152
    s_add_u32 s5, s5, s6
    s_lshl_b32 s6, s87, 7
    s_add_u32 s13, s5, s6
    s_mov_b32 s64, s36
    s_and_b32 s65, s37, 0xffff
    s_mov_b32 s66, 9216
    s_mov_b32 s67, 0x20000
    s_waitcnt vmcnt(0)
    v_dot2_f32_bf16 v14, v104, v108, v14
    v_dot2_f32_bf16 v14, v112, v116, v14
    v_dot2_f32_bf16 v14, v105, v109, v14
    v_dot2_f32_bf16 v14, v113, v117, v14
    v_dot2_f32_bf16 v14, v106, v110, v14
    v_dot2_f32_bf16 v14, v114, v118, v14
    v_dot2_f32_bf16 v14, v107, v111, v14
    v_dot2_f32_bf16 v14, v115, v119, v14
    s_nop 3
    v_add_f32_dpp v14, v14, v14 row_ror:1 row_mask:0xf bank_mask:0xf
    s_nop 1
    v_add_f32_dpp v14, v14, v14 row_ror:2 row_mask:0xf bank_mask:0xf
    s_nop 1
    v_add_f32_dpp v14, v14, v14 row_ror:4 row_mask:0xf bank_mask:0xf
    s_nop 1
    v_add_f32_dpp v14, v14, v14 row_ror:8 row_mask:0xf bank_mask:0xf
    s_nop 1
    v_mov_b32 v12, v14
    s_nop 1
    v_permlane32_swap_b32 v14, v12
    s_nop 1
    v_add_f32 v14, v14, v12
    v_mov_b32 v12, v14
    s_nop 1
    v_permlane16_swap_b32 v14, v12
    s_nop 1
    v_add_f32 v14, v14, v12
    v_mul_f32 v14, 0xbfb8aa3b, v14
    v_exp_f32 v14, v14
    s_nop 0
    v_add_f32 v14, 1.0, v14
    v_rcp_f32 v39, v14
    s_mov_b32 s85, 0
    buffer_load_dwordx4 v[72:75], v38, s[52:55], s89 offen sc1
    buffer_load_dwordx4 v[76:79], v38, s[52:55], s90 offen sc1
    buffer_load_dwordx4 v[80:83], v38, s[52:55], s91 offen sc1
    buffer_load_dwordx4 v[84:87], v44, s[52:55], s86 offen sc1
L_r_poll:
    s_waitcnt vmcnt(0)
    s_mov_b32 s5, 0
    v_xor_b32 v12, s84, v73
    v_bitop3_b32 v12, v75, s84, v12 bitop3:0xbe
    v_cmp_ne_u32 vcc, 0, v12
    s_cbranch_vccz L_rsk22
    s_cmp_lg_u32 s5, 0
    s_cbranch_scc1 L_rsl23
    s_sleep 2
L_rsl23:
    s_mov_b64 exec, vcc
    buffer_load_dwordx4 v[72:75], v38, s[52:55], s89 offen sc1
    s_mov_b64 exec, -1
    s_mov_b32 s5, 1
L_rsk22:
    v_xor_b32 v12, s84, v77
    v_bitop3_b32 v12, v79, s84, v12 bitop3:0xbe
    v_cmp_ne_u32 vcc, 0, v12
    s_cbranch_vccz L_rsk24
    s_cmp_lg_u32 s5, 0
    s_cbranch_scc1 L_rsl25
    s_sleep 2
L_rsl25:
    s_mov_b64 exec, vcc
    buffer_load_dwordx4 v[76:79], v38, s[52:55], s90 offen sc1
    s_mov_b64 exec, -1
    s_mov_b32 s5, 1
L_rsk24:
    v_xor_b32 v12, s84, v81
    v_bitop3_b32 v12, v83, s84, v12 bitop3:0xbe
    v_cmp_ne_u32 vcc, 0, v12
    s_cbranch_vccz L_rsk26
    s_cmp_lg_u32 s5, 0
    s_cbranch_scc1 L_rsl27
    s_sleep 2
L_rsl27:
    s_mov_b64 exec, vcc
    buffer_load_dwordx4 v[80:83], v38, s[52:55], s91 offen sc1
    s_mov_b64 exec, -1
    s_mov_b32 s5, 1
L_rsk26:
    v_xor_b32 v12, s84, v85
    v_bitop3_b32 v12, v87, s84, v12 bitop3:0xbe
    v_cmp_ne_u32 vcc, 0, v12
    s_cbranch_vccz L_rsk28
    s_cmp_lg_u32 s5, 0
    s_cbranch_scc1 L_rsl29
    s_sleep 2
L_rsl29:
    s_mov_b64 exec, vcc
    buffer_load_dwordx4 v[84:87], v44, s[52:55], s86 offen sc1
    s_mov_b64 exec, -1
    s_mov_b32 s5, 1
L_rsk28:
    s_cmp_eq_u32 s5, 0
    s_cbranch_scc1 L_r_ok0
    s_add_u32 s85, s85, 1
    s_cmp_gt_u32 s85, 4096
    s_cbranch_scc0 L_r_poll
L_r_ok0:
    v_add_f32 v72, v72, v76
    v_add_f32 v74, v74, v78
    s_mov_b64 exec, 0xff
    v_add_f32 v80, v80, v84
    v_add_f32 v82, v82, v86
    s_mov_b64 exec, -1
    v_sub_f32 v72, v72, v80
    v_sub_f32 v74, v74, v82
    v_fma_f32 v104, v72, v39, v80
    v_fma_f32 v105, v74, v39, v82
L_r_fin:
    s_nop 0
    v_add_f32_dpp v104, v104, v104 row_ror:8 row_mask:0xf bank_mask:0xf
    v_add_f32_dpp v105, v105, v105 row_ror:8 row_mask:0xf bank_mask:0xf
    v_mov_b32 v106, v104
    v_mov_b32 v107, v105
    s_nop 0
    v_permlane32_swap_b32 v104, v106
    v_permlane32_swap_b32 v105, v107
    s_nop 0
    v_add_f32 v104, v104, v106
    v_add_f32 v105, v105, v107
    v_mov_b32 v106, v104
    v_mov_b32 v107, v105
    s_nop 0
    v_permlane16_swap_b32 v104, v106
    v_permlane16_swap_b32 v105, v107
    s_nop 0
    v_add_f32 v104, v104, v106
    v_add_f32 v105, v105, v107
    v_cvt_pk_bf16_f32 v108, v104, v105
    s_mov_b64 exec, 0xff
    buffer_store_short v108, v45, s[64:67], s13 offen
    buffer_store_short_d16_hi v108, v45, s[64:67], s13 offen offset:16
    s_cmp_eq_u32 s14, 0
    s_cbranch_scc0 L_noepoch
    s_cmp_eq_u32 s3, 0
    s_cbranch_scc0 L_noepoch
    s_mov_b64 exec, 1
    v_mov_b32 v12, 0
    buffer_store_dword v7, v12, s[52:55], 0 offen
L_noepoch:
    s_mov_b64 exec, -1
L_fin:
L_end:
    s_endpgm

.section .rodata,"a"
.p2align 6
.amdhsa_kernel gated_mix__sliding_block_cached__swiglu_ffn__decode_kernel
  .amdhsa_next_free_vgpr 512
  .amdhsa_next_free_sgpr 102
  .amdhsa_accum_offset 256
  .amdhsa_group_segment_fixed_size 0
  .amdhsa_kernarg_size 104
  .amdhsa_user_sgpr_count 2
  .amdhsa_user_sgpr_kernarg_segment_ptr 1
  .amdhsa_system_sgpr_workgroup_id_x 1
.end_amdhsa_kernel
```
